```python
import torch

def _softmax(x, axis=-1):
    return torch.softmax(x, dim=axis)
def _gelu(x):
    return torch.nn.functional.gelu(x, approximate="tanh")
def _silu(x):
    return torch.nn.functional.silu(x)
def _sigmoid(x):
    return torch.sigmoid(x)
def _layernorm(x, axis=-1, eps=1e-5):
    m = x.mean(dim=axis, keepdim=True)
    v = x.var(dim=axis, keepdim=True, unbiased=False)
    return (x - m) / torch.sqrt(v + eps)
def _scatter_add(tgt, idx, src, axis=0):
    return tgt.clone().index_add_(axis, idx, src)
def _segment_sum(src, seg, n):
    out = torch.zeros((n,) + src.shape[1:], dtype=src.dtype)
    return out.index_add_(0, seg, src)
def _pad(x, pw):
    flat = tuple(v for pair in reversed(pw) for v in pair)
    return torch.nn.functional.pad(x, flat)

kernel_name = 'sequential_preLN__spectral_gfnet__geglu_ffn__prompt'

def setup_inputs():

    _w = (lambda a: (lambda t: t.to(torch.bfloat16) if t.is_floating_point() else t)(torch.as_tensor(a)))
    def _A_setup():
        B, S, D = 1, 2048, 640
        Df = D // 2 + 1
        return {
            "x": _w((lambda *s: torch.randn(*s, dtype=torch.bfloat16) * 0.05)(B, S, D)),
            "w_r": _w((lambda *s: torch.randn(*s, dtype=torch.bfloat16) * 0.4)(S, Df) * 0.02),
            "w_i": _w((lambda *s: torch.randn(*s, dtype=torch.bfloat16) * 0.4)(S, Df) * 0.02),
        }
    _A_in = _A_setup()

    def _B_setup():
        B, S, D, F = 1, 2048, 640, 1536
        return {
            "x": _w((lambda *s: torch.randn(*s, dtype=torch.bfloat16) * 0.05)(B, S, D)),
            "w_gate": _w((lambda *s: torch.randn(*s, dtype=torch.bfloat16) * 0.05)(D, F)),
            "w_up": _w((lambda *s: torch.randn(*s, dtype=torch.bfloat16) * 0.05)(D, F)),
            "w_down": _w((lambda *s: torch.randn(*s, dtype=torch.bfloat16) * 0.05)(F, D)),
        }
    _B_in = _B_setup()

    return {
        "A_x": _A_in["x"],
        "A_w_r": _A_in["w_r"],
        "A_w_i": _A_in["w_i"],
        "B_x": _B_in["x"],
        "B_w_gate": _B_in["w_gate"],
        "B_w_up": _B_in["w_up"],
        "B_w_down": _B_in["w_down"],
    }

def reference(A_x, A_w_r, A_w_i, B_x, B_w_gate, B_w_up, B_w_down):
    def _A_ref(x, w_r, w_i):
        B, S, D = x.shape
        X = (lambda x, axes=(-2,-1): torch.fft.rfft2(x.float(), dim=axes))(x, axes=(-2, -1))
        W = w_r + 1j * w_i
        X = X * W
        y = (lambda x, s, axes=(-2,-1): torch.fft.irfft2(x, s=s, dim=axes).to(torch.bfloat16))(X, (S, D), axes=(-2, -1))
        return y

    def _B_ref(x, w_gate, w_up, w_down):
        return (_gelu(x @ w_gate) * (x @ w_up)) @ w_down

    x = A_x
    h = x + _A_ref(_layernorm(x, axis=-1), A_w_r, A_w_i)
    h2 = h + _B_ref(_layernorm(h, axis=-1), B_w_gate, B_w_up, B_w_down)
    return h2
```

```asm
; @launch kernel=k1_kernel grid=(352,1,1) block=(512,1,1) lds=53760
; @launch kernel=k2_kernel grid=(501,1,1) block=(256,1,1) lds=36864
; @launch kernel=k3_kernel grid=(256,1,1) block=(512,1,1) lds=53760
; @launch kernel=k4_kernel grid=(256,1,1) block=(512,1,1) lds=122880
; @launch kernel=k5_kernel grid=(256,1,1) block=(256,1,1) lds=81920
.amdgcn_target "amdgcn-amd-amdhsa--gfx950"
.text
.globl k1_kernel
.p2align 8
.type k1_kernel,@function
k1_kernel:
    s_load_dwordx2 s[4:5], s[0:1], 0
    s_load_dwordx4 s[8:11], s[0:1], 8
    s_load_dwordx2 s[6:7], s[0:1], 72
    v_and_b32 v1, 63, v0
    v_lshrrev_b32 v2, 6, v0
    s_nop 0
    v_readfirstlane_b32 s3, v2
    s_cmp_ge_u32 s2, 256
    s_cbranch_scc1 L_k1wt_1
    s_mov_b32 s40, 0x3f3504f3
    s_mov_b32 s41, 0x3f3504f3
    s_mov_b32 s42, 0x3e9e377a
    s_mov_b32 s43, 0x3e9e377a
    s_mov_b32 s44, 0xbf4f1bbd
    s_mov_b32 s45, 0xbf4f1bbd
    s_mov_b32 s46, 0x3f737871
    s_mov_b32 s47, 0x3f737871
    s_mov_b32 s48, 0x3f167918
    s_mov_b32 s49, 0x3f167918
    s_mov_b32 s50, 0x3acccccd
    s_and_b32 s12, s2, 7
    s_lshl_b32 s12, s12, 5
    s_lshr_b32 s13, s2, 3
    s_add_u32 s51, s12, s13
    s_lshl_b32 s12, s51, 3
    s_add_u32 s12, s12, s3
    s_mul_i32 s13, s12, 1280
    v_lshlrev_b32 v3, 2, v1
    s_waitcnt lgkmcnt(0)
    s_mov_b32 s16, s4
    s_and_b32 s17, s5, 0xffff
    s_mov_b32 s18, 0x280000
    s_mov_b32 s19, 0x00020000
    s_add_u32 s20, s6, 0x0
    s_addc_u32 s21, s7, 0
    s_and_b32 s21, s21, 0xffff
    s_mov_b32 s22, 0x504000
    s_mov_b32 s23, 0x00020000
    buffer_load_dword v5, v3, s[16:19], s13 offen offset:0
    buffer_load_dword v6, v3, s[16:19], s13 offen offset:256
    buffer_load_dword v7, v3, s[16:19], s13 offen offset:512
    buffer_load_dword v8, v3, s[16:19], s13 offen offset:768
    buffer_load_dword v9, v3, s[16:19], s13 offen offset:1024
    v_cvt_f32_u32 v4, v1
    v_mul_f32 v10, 0xbb4ccccd, v4
    v_cos_f32 v40, v10
    v_sin_f32 v41, v10
    s_nop 0
    v_pk_mul_f32 v[12:13], v[40:41], v[40:41] op_sel:[0,0] op_sel_hi:[1,0]
    v_pk_fma_f32 v[42:43], v[40:41], v[40:41], v[12:13] op_sel:[1,1,0] op_sel_hi:[0,1,1] neg_lo:[0,1,0]
    v_pk_mul_f32 v[12:13], v[40:41], v[42:43] op_sel:[0,0] op_sel_hi:[1,0]
    v_pk_fma_f32 v[44:45], v[40:41], v[42:43], v[12:13] op_sel:[1,1,0] op_sel_hi:[0,1,1] neg_lo:[0,1,0]
    v_pk_mul_f32 v[12:13], v[42:43], v[42:43] op_sel:[0,0] op_sel_hi:[1,0]
    v_pk_fma_f32 v[46:47], v[42:43], v[42:43], v[12:13] op_sel:[1,1,0] op_sel_hi:[0,1,1] neg_lo:[0,1,0]
    v_and_b32 v10, 7, v1
    v_cvt_f32_u32 v10, v10
    v_mul_f32 v10, 0xbc800000, v10
    v_cos_f32 v48, v10
    v_sin_f32 v49, v10
    s_nop 0
    v_pk_mul_f32 v[12:13], v[48:49], v[48:49] op_sel:[0,0] op_sel_hi:[1,0]
    v_pk_fma_f32 v[50:51], v[48:49], v[48:49], v[12:13] op_sel:[1,1,0] op_sel_hi:[0,1,1] neg_lo:[0,1,0]
    v_pk_mul_f32 v[12:13], v[48:49], v[50:51] op_sel:[0,0] op_sel_hi:[1,0]
    v_pk_fma_f32 v[52:53], v[48:49], v[50:51], v[12:13] op_sel:[1,1,0] op_sel_hi:[0,1,1] neg_lo:[0,1,0]
    v_pk_mul_f32 v[12:13], v[50:51], v[50:51] op_sel:[0,0] op_sel_hi:[1,0]
    v_pk_fma_f32 v[54:55], v[50:51], v[50:51], v[12:13] op_sel:[1,1,0] op_sel_hi:[0,1,1] neg_lo:[0,1,0]
    v_pk_mul_f32 v[12:13], v[50:51], v[52:53] op_sel:[0,0] op_sel_hi:[1,0]
    v_pk_fma_f32 v[56:57], v[50:51], v[52:53], v[12:13] op_sel:[1,1,0] op_sel_hi:[0,1,1] neg_lo:[0,1,0]
    v_pk_mul_f32 v[12:13], v[52:53], v[52:53] op_sel:[0,0] op_sel_hi:[1,0]
    v_pk_fma_f32 v[58:59], v[52:53], v[52:53], v[12:13] op_sel:[1,1,0] op_sel_hi:[0,1,1] neg_lo:[0,1,0]
    v_pk_mul_f32 v[12:13], v[52:53], v[54:55] op_sel:[0,0] op_sel_hi:[1,0]
    v_pk_fma_f32 v[60:61], v[52:53], v[54:55], v[12:13] op_sel:[1,1,0] op_sel_hi:[0,1,1] neg_lo:[0,1,0]
    v_mov_b32 v10, 0x3f000000
    v_fmac_f32 v10, 0x3acccccd, v4
    v_sin_f32 v62, v10
    v_cos_f32 v63, v10
    v_mov_b32 v10, 0x3f19999a
    v_fmac_f32 v10, 0x3acccccd, v4
    v_sin_f32 v64, v10
    v_cos_f32 v65, v10
    v_mov_b32 v10, 0x3f333333
    v_fmac_f32 v10, 0x3acccccd, v4
    v_sin_f32 v66, v10
    v_cos_f32 v67, v10
    v_mov_b32 v10, 0x3f4ccccd
    v_fmac_f32 v10, 0x3acccccd, v4
    v_sin_f32 v68, v10
    v_cos_f32 v69, v10
    v_mov_b32 v10, 0x3f666666
    v_fmac_f32 v10, 0x3acccccd, v4
    v_sin_f32 v70, v10
    v_cos_f32 v71, v10
    s_mul_i32 s14, s3, 2880
    v_lshlrev_b32 v72, 3, v1
    v_add_u32 v72, s14, v72
    v_lshrrev_b32 v73, 3, v1
    v_mul_u32_u24 v74, 576, v73
    v_and_b32 v75, 7, v1
    v_lshlrev_b32 v76, 3, v75
    v_add3_u32 v76, v74, v76, s14
    v_mul_u32_u24 v77, 72, v75
    v_add3_u32 v77, v74, v77, s14
    v_mul_u32_u24 v78, 5, v75
    v_add_u32 v78, v78, v73
    v_lshlrev_b32 v78, 3, v78
    v_add_u32 v78, s14, v78
    v_sub_u32 v79, 320, v1
    v_lshlrev_b32 v79, 3, v79
    v_add_u32 v79, s14, v79
    v_mul_u32_u24 v80, 80, v1
    s_lshl_b32 s15, s3, 3
    s_add_u32 s15, s15, 23040
    v_add_u32 v80, s15, v80
    s_waitcnt vmcnt(0)
    v_lshlrev_b32 v14, 16, v5
    v_and_b32 v15, 0xffff0000, v5
    v_lshlrev_b32 v16, 16, v6
    v_and_b32 v17, 0xffff0000, v6
    v_lshlrev_b32 v18, 16, v7
    v_and_b32 v19, 0xffff0000, v7
    v_lshlrev_b32 v20, 16, v8
    v_and_b32 v21, 0xffff0000, v8
    v_lshlrev_b32 v22, 16, v9
    v_and_b32 v23, 0xffff0000, v9
    v_pk_add_f32 v[24:25], v[14:15], v[16:17]
    v_pk_add_f32 v[26:27], v[18:19], v[20:21]
    v_pk_add_f32 v[24:25], v[24:25], v[22:23]
    v_pk_add_f32 v[24:25], v[24:25], v[26:27]
    v_add_f32 v24, v24, v25
    s_nop 1
    v_add_f32_dpp v24, v24, v24 quad_perm:[1,0,3,2] row_mask:0xf bank_mask:0xf
    s_nop 1
    v_add_f32_dpp v24, v24, v24 quad_perm:[2,3,0,1] row_mask:0xf bank_mask:0xf
    s_nop 1
    v_add_f32_dpp v24, v24, v24 row_half_mirror row_mask:0xf bank_mask:0xf
    s_nop 1
    v_add_f32_dpp v24, v24, v24 row_mirror row_mask:0xf bank_mask:0xf
    s_nop 1
    v_add_f32_dpp v24, v24, v24 row_bcast:15 row_mask:0xa bank_mask:0xf
    s_nop 1
    v_add_f32_dpp v24, v24, v24 row_bcast:31 row_mask:0xc bank_mask:0xf
    s_nop 1
    v_readlane_b32 s38, v24, 63
    s_nop 1
    v_mov_b32 v30, s50
    v_mul_f32 v30, s38, v30
    v_mov_b32 v31, v30
    v_pk_add_f32 v[26:27], v[14:15], v[30:31] neg_lo:[0,1] neg_hi:[0,1]
    v_pk_mul_f32 v[24:25], v[26:27], v[26:27]
    v_pk_add_f32 v[26:27], v[16:17], v[30:31] neg_lo:[0,1] neg_hi:[0,1]
    v_pk_fma_f32 v[24:25], v[26:27], v[26:27], v[24:25]
    v_pk_add_f32 v[26:27], v[18:19], v[30:31] neg_lo:[0,1] neg_hi:[0,1]
    v_pk_fma_f32 v[24:25], v[26:27], v[26:27], v[24:25]
    v_pk_add_f32 v[26:27], v[20:21], v[30:31] neg_lo:[0,1] neg_hi:[0,1]
    v_pk_fma_f32 v[24:25], v[26:27], v[26:27], v[24:25]
    v_pk_add_f32 v[26:27], v[22:23], v[30:31] neg_lo:[0,1] neg_hi:[0,1]
    v_pk_fma_f32 v[24:25], v[26:27], v[26:27], v[24:25]
    v_add_f32 v24, v24, v25
    s_nop 1
    v_add_f32_dpp v24, v24, v24 quad_perm:[1,0,3,2] row_mask:0xf bank_mask:0xf
    s_nop 1
    v_add_f32_dpp v24, v24, v24 quad_perm:[2,3,0,1] row_mask:0xf bank_mask:0xf
    s_nop 1
    v_add_f32_dpp v24, v24, v24 row_half_mirror row_mask:0xf bank_mask:0xf
    s_nop 1
    v_add_f32_dpp v24, v24, v24 row_mirror row_mask:0xf bank_mask:0xf
    s_nop 1
    v_add_f32_dpp v24, v24, v24 row_bcast:15 row_mask:0xa bank_mask:0xf
    s_nop 1
    v_add_f32_dpp v24, v24, v24 row_bcast:31 row_mask:0xc bank_mask:0xf
    s_nop 1
    v_readlane_b32 s38, v24, 63
    s_nop 1
    v_mov_b32 v28, s50
    v_mul_f32 v28, s38, v28
    v_cvt_pk_bf16_f32 v28, v28, v30
    v_and_b32 v30, 0xffff0000, v28
    v_mov_b32 v31, v30
    v_lshlrev_b32 v28, 16, v28
    v_add_f32 v28, 0x3727c5ac, v28
    v_cvt_pk_bf16_f32 v28, v28, v28
    v_lshlrev_b32 v28, 16, v28
    v_sqrt_f32 v28, v28
    s_nop 0
    v_cvt_pk_bf16_f32 v28, v28, v28
    v_lshlrev_b32 v28, 16, v28
    v_rcp_f32 v29, v28
    s_nop 0
    v_fma_f32 v28, -v28, v29, 2.0
    v_mul_f32 v28, v28, v29
    v_mov_b32 v29, v28
    v_pk_add_f32 v[14:15], v[14:15], v[30:31] neg_lo:[0,1] neg_hi:[0,1]
    v_cvt_pk_bf16_f32 v15, v14, v15
    v_lshlrev_b32 v14, 16, v15
    v_and_b32 v15, 0xffff0000, v15
    v_pk_mul_f32 v[14:15], v[14:15], v[28:29]
    v_cvt_pk_bf16_f32 v32, v14, v15
    v_lshlrev_b32 v14, 16, v32
    v_and_b32 v15, 0xffff0000, v32
    v_pk_add_f32 v[16:17], v[16:17], v[30:31] neg_lo:[0,1] neg_hi:[0,1]
    v_cvt_pk_bf16_f32 v17, v16, v17
    v_lshlrev_b32 v16, 16, v17
    v_and_b32 v17, 0xffff0000, v17
    v_pk_mul_f32 v[16:17], v[16:17], v[28:29]
    v_cvt_pk_bf16_f32 v33, v16, v17
    v_lshlrev_b32 v16, 16, v33
    v_and_b32 v17, 0xffff0000, v33
    v_pk_add_f32 v[18:19], v[18:19], v[30:31] neg_lo:[0,1] neg_hi:[0,1]
    v_cvt_pk_bf16_f32 v19, v18, v19
    v_lshlrev_b32 v18, 16, v19
    v_and_b32 v19, 0xffff0000, v19
    v_pk_mul_f32 v[18:19], v[18:19], v[28:29]
    v_cvt_pk_bf16_f32 v34, v18, v19
    v_lshlrev_b32 v18, 16, v34
    v_and_b32 v19, 0xffff0000, v34
    v_pk_add_f32 v[20:21], v[20:21], v[30:31] neg_lo:[0,1] neg_hi:[0,1]
    v_cvt_pk_bf16_f32 v21, v20, v21
    v_lshlrev_b32 v20, 16, v21
    v_and_b32 v21, 0xffff0000, v21
    v_pk_mul_f32 v[20:21], v[20:21], v[28:29]
    v_cvt_pk_bf16_f32 v35, v20, v21
    v_lshlrev_b32 v20, 16, v35
    v_and_b32 v21, 0xffff0000, v35
    v_pk_add_f32 v[22:23], v[22:23], v[30:31] neg_lo:[0,1] neg_hi:[0,1]
    v_cvt_pk_bf16_f32 v23, v22, v23
    v_lshlrev_b32 v22, 16, v23
    v_and_b32 v23, 0xffff0000, v23
    v_pk_mul_f32 v[22:23], v[22:23], v[28:29]
    v_cvt_pk_bf16_f32 v36, v22, v23
    v_lshlrev_b32 v22, 16, v36
    v_and_b32 v23, 0xffff0000, v36
    v_pk_add_f32 v[38:39], v[16:17], v[22:23] neg_lo:[0,1] neg_hi:[0,1]
    v_pk_add_f32 v[16:17], v[16:17], v[22:23]
    v_pk_add_f32 v[22:23], v[18:19], v[20:21] neg_lo:[0,1] neg_hi:[0,1]
    v_pk_add_f32 v[18:19], v[18:19], v[20:21]
    v_pk_fma_f32 v[20:21], v[16:17], s[42:43], v[14:15] op_sel_hi:[1,0,1]
    v_pk_fma_f32 v[36:37], v[16:17], s[44:45], v[14:15] op_sel_hi:[1,0,1]
    v_pk_fma_f32 v[20:21], v[18:19], s[44:45], v[20:21] op_sel_hi:[1,0,1]
    v_pk_fma_f32 v[36:37], v[18:19], s[42:43], v[36:37] op_sel_hi:[1,0,1]
    v_pk_add_f32 v[14:15], v[14:15], v[16:17]
    v_pk_add_f32 v[14:15], v[14:15], v[18:19]
    v_pk_mul_f32 v[16:17], v[38:39], s[46:47] op_sel_hi:[1,0]
    v_pk_mul_f32 v[18:19], v[38:39], s[48:49] op_sel_hi:[1,0]
    v_pk_fma_f32 v[16:17], v[22:23], s[48:49], v[16:17] op_sel_hi:[1,0,1]
    v_pk_fma_f32 v[18:19], v[22:23], s[46:47], v[18:19] op_sel_hi:[1,0,1] neg_lo:[1,0,0] neg_hi:[1,0,0]
    v_pk_add_f32 v[38:39], v[20:21], v[16:17] op_sel:[0,1] op_sel_hi:[1,0] neg_lo:[0,1]
    v_pk_add_f32 v[20:21], v[20:21], v[16:17] op_sel:[0,1] op_sel_hi:[1,0] neg_hi:[0,1]
    v_pk_add_f32 v[22:23], v[36:37], v[18:19] op_sel:[0,1] op_sel_hi:[1,0] neg_lo:[0,1]
    v_pk_add_f32 v[36:37], v[36:37], v[18:19] op_sel:[0,1] op_sel_hi:[1,0] neg_hi:[0,1]
    v_pk_mul_f32 v[18:19], v[20:21], v[40:41] op_sel:[0,0] op_sel_hi:[1,0]
    v_pk_fma_f32 v[20:21], v[20:21], v[40:41], v[18:19] op_sel:[1,1,0] op_sel_hi:[0,1,1] neg_lo:[0,1,0]
    v_pk_mul_f32 v[18:19], v[36:37], v[42:43] op_sel:[0,0] op_sel_hi:[1,0]
    v_pk_fma_f32 v[36:37], v[36:37], v[42:43], v[18:19] op_sel:[1,1,0] op_sel_hi:[0,1,1] neg_lo:[0,1,0]
    v_pk_mul_f32 v[18:19], v[22:23], v[44:45] op_sel:[0,0] op_sel_hi:[1,0]
    v_pk_fma_f32 v[22:23], v[22:23], v[44:45], v[18:19] op_sel:[1,1,0] op_sel_hi:[0,1,1] neg_lo:[0,1,0]
    v_pk_mul_f32 v[18:19], v[38:39], v[46:47] op_sel:[0,0] op_sel_hi:[1,0]
    v_pk_fma_f32 v[38:39], v[38:39], v[46:47], v[18:19] op_sel:[1,1,0] op_sel_hi:[0,1,1] neg_lo:[0,1,0]
    ds_write_b64 v72, v[14:15] offset:0
    ds_write_b64 v72, v[20:21] offset:576
    ds_write_b64 v72, v[36:37] offset:1152
    ds_write_b64 v72, v[22:23] offset:1728
    ds_write_b64 v72, v[38:39] offset:2304
    s_waitcnt lgkmcnt(0)
    ds_read_b64 v[38:39], v76 offset:0
    ds_read_b64 v[22:23], v76 offset:64
    ds_read_b64 v[36:37], v76 offset:128
    ds_read_b64 v[20:21], v76 offset:192
    ds_read_b64 v[14:15], v76 offset:256
    ds_read_b64 v[18:19], v76 offset:320
    ds_read_b64 v[16:17], v76 offset:384
    ds_read_b64 v[34:35], v76 offset:448
    s_waitcnt lgkmcnt(0)
    v_pk_add_f32 v[32:33], v[38:39], v[14:15] neg_lo:[0,1] neg_hi:[0,1]
    v_pk_add_f32 v[38:39], v[38:39], v[14:15]
    v_pk_add_f32 v[14:15], v[22:23], v[18:19] neg_lo:[0,1] neg_hi:[0,1]
    v_pk_add_f32 v[22:23], v[22:23], v[18:19]
    v_pk_add_f32 v[18:19], v[36:37], v[16:17] neg_lo:[0,1] neg_hi:[0,1]
    v_pk_add_f32 v[36:37], v[36:37], v[16:17]
    v_pk_add_f32 v[16:17], v[20:21], v[34:35] neg_lo:[0,1] neg_hi:[0,1]
    v_pk_add_f32 v[20:21], v[20:21], v[34:35]
    v_pk_add_f32 v[34:35], v[38:39], v[36:37] neg_lo:[0,1] neg_hi:[0,1]
    v_pk_add_f32 v[38:39], v[38:39], v[36:37]
    v_pk_add_f32 v[36:37], v[22:23], v[20:21] neg_lo:[0,1] neg_hi:[0,1]
    v_pk_add_f32 v[22:23], v[22:23], v[20:21]
    v_pk_add_f32 v[20:21], v[38:39], v[22:23] neg_lo:[0,1] neg_hi:[0,1]
    v_pk_add_f32 v[38:39], v[38:39], v[22:23]
    v_pk_add_f32 v[22:23], v[34:35], v[36:37] op_sel:[0,1] op_sel_hi:[1,0] neg_lo:[0,1]
    v_pk_add_f32 v[34:35], v[34:35], v[36:37] op_sel:[0,1] op_sel_hi:[1,0] neg_hi:[0,1]
    v_pk_add_f32 v[14:15], v[14:15], v[14:15] op_sel:[0,1] op_sel_hi:[1,0] neg_hi:[0,1]
    v_pk_add_f32 v[16:17], v[16:17], v[16:17] op_sel:[0,1] op_sel_hi:[1,0] neg_lo:[0,1]
    v_pk_add_f32 v[36:37], v[32:33], v[18:19] op_sel:[0,1] op_sel_hi:[1,0] neg_lo:[0,1]
    v_pk_add_f32 v[32:33], v[32:33], v[18:19] op_sel:[0,1] op_sel_hi:[1,0] neg_hi:[0,1]
    v_pk_add_f32 v[18:19], v[14:15], v[16:17] neg_lo:[0,1] neg_hi:[0,1]
    v_pk_add_f32 v[14:15], v[14:15], v[16:17]
    v_pk_fma_f32 v[16:17], v[18:19], s[40:41], v[32:33] op_sel_hi:[1,0,1] neg_lo:[1,0,0] neg_hi:[1,0,0]
    v_pk_fma_f32 v[32:33], v[18:19], s[40:41], v[32:33] op_sel_hi:[1,0,1]
    v_pk_fma_f32 v[18:19], v[14:15], s[40:41], v[36:37] op_sel:[1,0,0] op_sel_hi:[0,0,1] neg_lo:[1,0,0]
    v_pk_fma_f32 v[36:37], v[14:15], s[40:41], v[36:37] op_sel:[1,0,0] op_sel_hi:[0,0,1] neg_hi:[1,0,0]
    v_pk_mul_f32 v[14:15], v[32:33], v[48:49] op_sel:[0,0] op_sel_hi:[1,0]
    v_pk_fma_f32 v[32:33], v[32:33], v[48:49], v[14:15] op_sel:[1,1,0] op_sel_hi:[0,1,1] neg_lo:[0,1,0]
    v_pk_mul_f32 v[14:15], v[34:35], v[50:51] op_sel:[0,0] op_sel_hi:[1,0]
    v_pk_fma_f32 v[34:35], v[34:35], v[50:51], v[14:15] op_sel:[1,1,0] op_sel_hi:[0,1,1] neg_lo:[0,1,0]
    v_pk_mul_f32 v[14:15], v[36:37], v[52:53] op_sel:[0,0] op_sel_hi:[1,0]
    v_pk_fma_f32 v[36:37], v[36:37], v[52:53], v[14:15] op_sel:[1,1,0] op_sel_hi:[0,1,1] neg_lo:[0,1,0]
    v_pk_mul_f32 v[14:15], v[20:21], v[54:55] op_sel:[0,0] op_sel_hi:[1,0]
    v_pk_fma_f32 v[20:21], v[20:21], v[54:55], v[14:15] op_sel:[1,1,0] op_sel_hi:[0,1,1] neg_lo:[0,1,0]
    v_pk_mul_f32 v[14:15], v[16:17], v[56:57] op_sel:[0,0] op_sel_hi:[1,0]
    v_pk_fma_f32 v[16:17], v[16:17], v[56:57], v[14:15] op_sel:[1,1,0] op_sel_hi:[0,1,1] neg_lo:[0,1,0]
    v_pk_mul_f32 v[14:15], v[22:23], v[58:59] op_sel:[0,0] op_sel_hi:[1,0]
    v_pk_fma_f32 v[22:23], v[22:23], v[58:59], v[14:15] op_sel:[1,1,0] op_sel_hi:[0,1,1] neg_lo:[0,1,0]
    v_pk_mul_f32 v[14:15], v[18:19], v[60:61] op_sel:[0,0] op_sel_hi:[1,0]
    v_pk_fma_f32 v[18:19], v[18:19], v[60:61], v[14:15] op_sel:[1,1,0] op_sel_hi:[0,1,1] neg_lo:[0,1,0]
    v_cmp_gt_u32 vcc, 40, v1
    s_and_saveexec_b64 s[32:33], vcc
    ds_write_b64 v76, v[38:39] offset:0
    ds_write_b64 v76, v[32:33] offset:72
    ds_write_b64 v76, v[34:35] offset:144
    ds_write_b64 v76, v[36:37] offset:216
    ds_write_b64 v76, v[20:21] offset:288
    ds_write_b64 v76, v[16:17] offset:360
    ds_write_b64 v76, v[22:23] offset:432
    ds_write_b64 v76, v[18:19] offset:504
    s_mov_b64 exec, s[32:33]
    s_waitcnt lgkmcnt(0)
    ds_read_b64 v[18:19], v77 offset:0
    ds_read_b64 v[22:23], v77 offset:8
    ds_read_b64 v[16:17], v77 offset:16
    ds_read_b64 v[20:21], v77 offset:24
    ds_read_b64 v[36:37], v77 offset:32
    ds_read_b64 v[34:35], v77 offset:40
    ds_read_b64 v[32:33], v77 offset:48
    ds_read_b64 v[38:39], v77 offset:56
    s_waitcnt lgkmcnt(0)
    v_pk_add_f32 v[14:15], v[18:19], v[36:37] neg_lo:[0,1] neg_hi:[0,1]
    v_pk_add_f32 v[18:19], v[18:19], v[36:37]
    v_pk_add_f32 v[36:37], v[22:23], v[34:35] neg_lo:[0,1] neg_hi:[0,1]
    v_pk_add_f32 v[22:23], v[22:23], v[34:35]
    v_pk_add_f32 v[34:35], v[16:17], v[32:33] neg_lo:[0,1] neg_hi:[0,1]
    v_pk_add_f32 v[16:17], v[16:17], v[32:33]
    v_pk_add_f32 v[32:33], v[20:21], v[38:39] neg_lo:[0,1] neg_hi:[0,1]
    v_pk_add_f32 v[20:21], v[20:21], v[38:39]
    v_pk_add_f32 v[38:39], v[18:19], v[16:17] neg_lo:[0,1] neg_hi:[0,1]
    v_pk_add_f32 v[18:19], v[18:19], v[16:17]
    v_pk_add_f32 v[16:17], v[22:23], v[20:21] neg_lo:[0,1] neg_hi:[0,1]
    v_pk_add_f32 v[22:23], v[22:23], v[20:21]
    v_pk_add_f32 v[20:21], v[18:19], v[22:23] neg_lo:[0,1] neg_hi:[0,1]
    v_pk_add_f32 v[18:19], v[18:19], v[22:23]
    v_pk_add_f32 v[22:23], v[38:39], v[16:17] op_sel:[0,1] op_sel_hi:[1,0] neg_lo:[0,1]
    v_pk_add_f32 v[38:39], v[38:39], v[16:17] op_sel:[0,1] op_sel_hi:[1,0] neg_hi:[0,1]
    v_pk_add_f32 v[36:37], v[36:37], v[36:37] op_sel:[0,1] op_sel_hi:[1,0] neg_hi:[0,1]
    v_pk_add_f32 v[32:33], v[32:33], v[32:33] op_sel:[0,1] op_sel_hi:[1,0] neg_lo:[0,1]
    v_pk_add_f32 v[16:17], v[14:15], v[34:35] op_sel:[0,1] op_sel_hi:[1,0] neg_lo:[0,1]
    v_pk_add_f32 v[14:15], v[14:15], v[34:35] op_sel:[0,1] op_sel_hi:[1,0] neg_hi:[0,1]
    v_pk_add_f32 v[34:35], v[36:37], v[32:33] neg_lo:[0,1] neg_hi:[0,1]
    v_pk_add_f32 v[36:37], v[36:37], v[32:33]
    v_pk_fma_f32 v[32:33], v[34:35], s[40:41], v[14:15] op_sel_hi:[1,0,1] neg_lo:[1,0,0] neg_hi:[1,0,0]
    v_pk_fma_f32 v[14:15], v[34:35], s[40:41], v[14:15] op_sel_hi:[1,0,1]
    v_pk_fma_f32 v[34:35], v[36:37], s[40:41], v[16:17] op_sel:[1,0,0] op_sel_hi:[0,0,1] neg_lo:[1,0,0]
    v_pk_fma_f32 v[16:17], v[36:37], s[40:41], v[16:17] op_sel:[1,0,0] op_sel_hi:[0,0,1] neg_hi:[1,0,0]
    s_mov_b64 exec, vcc
    ds_write_b64 v78, v[18:19] offset:0
    ds_write_b64 v78, v[14:15] offset:320
    ds_write_b64 v78, v[38:39] offset:640
    ds_write_b64 v78, v[16:17] offset:960
    ds_write_b64 v78, v[20:21] offset:1280
    ds_write_b64 v78, v[32:33] offset:1600
    ds_write_b64 v78, v[22:23] offset:1920
    ds_write_b64 v78, v[34:35] offset:2240
    s_mov_b64 exec, 1
    ds_write_b64 v78, v[18:19] offset:2560
    s_mov_b64 exec, s[32:33]
    s_waitcnt lgkmcnt(0)
    v_subrev_u32 v81, 2048, v79
    ds_read_b64 v[34:35], v72 offset:0
    ds_read_b64 v[38:39], v81 offset:2048
    ds_read_b64 v[22:23], v72 offset:512
    ds_read_b64 v[14:15], v81 offset:1536
    ds_read_b64 v[32:33], v72 offset:1024
    ds_read_b64 v[18:19], v81 offset:1024
    ds_read_b64 v[20:21], v72 offset:1536
    ds_read_b64 v[36:37], v81 offset:512
    ds_read_b64 v[16:17], v72 offset:2048
    ds_read_b64 v[30:31], v81 offset:0
    s_waitcnt lgkmcnt(0)
    v_pk_add_f32 v[28:29], v[34:35], v[38:39] neg_hi:[0,1]
    v_pk_add_f32 v[34:35], v[34:35], v[38:39] neg_lo:[0,1]
    v_sub_f32 v38, v28, v35
    v_mov_b32 v39, 0
    v_pk_fma_f32 v[26:27], v[34:35], v[62:63], v[28:29] op_sel:[0,0,0] op_sel_hi:[1,0,1]
    v_pk_fma_f32 v[34:35], v[34:35], v[62:63], v[26:27] op_sel:[1,1,0] op_sel_hi:[0,1,1] neg_lo:[0,1,0]
    ds_write_b64 v80, v[34:35] offset:0
    s_mov_b64 exec, 1
    ds_write_b64 v80, v[38:39] offset:25600
    s_mov_b64 exec, s[32:33]
    v_pk_add_f32 v[28:29], v[22:23], v[14:15] neg_hi:[0,1]
    v_pk_add_f32 v[22:23], v[22:23], v[14:15] neg_lo:[0,1]
    v_pk_fma_f32 v[26:27], v[22:23], v[64:65], v[28:29] op_sel:[0,0,0] op_sel_hi:[1,0,1]
    v_pk_fma_f32 v[22:23], v[22:23], v[64:65], v[26:27] op_sel:[1,1,0] op_sel_hi:[0,1,1] neg_lo:[0,1,0]
    ds_write_b64 v80, v[22:23] offset:5120
    v_pk_add_f32 v[28:29], v[32:33], v[18:19] neg_hi:[0,1]
    v_pk_add_f32 v[32:33], v[32:33], v[18:19] neg_lo:[0,1]
    v_pk_fma_f32 v[26:27], v[32:33], v[66:67], v[28:29] op_sel:[0,0,0] op_sel_hi:[1,0,1]
    v_pk_fma_f32 v[32:33], v[32:33], v[66:67], v[26:27] op_sel:[1,1,0] op_sel_hi:[0,1,1] neg_lo:[0,1,0]
    ds_write_b64 v80, v[32:33] offset:10240
    v_pk_add_f32 v[28:29], v[20:21], v[36:37] neg_hi:[0,1]
    v_pk_add_f32 v[20:21], v[20:21], v[36:37] neg_lo:[0,1]
    v_pk_fma_f32 v[26:27], v[20:21], v[68:69], v[28:29] op_sel:[0,0,0] op_sel_hi:[1,0,1]
    v_pk_fma_f32 v[20:21], v[20:21], v[68:69], v[26:27] op_sel:[1,1,0] op_sel_hi:[0,1,1] neg_lo:[0,1,0]
    ds_write_b64 v80, v[20:21] offset:15360
    v_pk_add_f32 v[28:29], v[16:17], v[30:31] neg_hi:[0,1]
    v_pk_add_f32 v[16:17], v[16:17], v[30:31] neg_lo:[0,1]
    v_pk_fma_f32 v[26:27], v[16:17], v[70:71], v[28:29] op_sel:[0,0,0] op_sel_hi:[1,0,1]
    v_pk_fma_f32 v[16:17], v[16:17], v[70:71], v[26:27] op_sel:[1,1,0] op_sel_hi:[0,1,1] neg_lo:[0,1,0]
    ds_write_b64 v80, v[16:17] offset:20480
    s_waitcnt lgkmcnt(0)
    s_barrier
    v_lshrrev_b32 v4, 2, v0
    v_and_b32 v5, 3, v0
    v_mul_u32_u24 v6, 80, v4
    v_lshlrev_b32 v5, 4, v5
    v_add3_u32 v6, v6, v5, 0
    v_add_u32 v6, 23040, v6
    v_lshlrev_b32 v7, 14, v4
    v_add_u32 v7, v7, v5
    s_lshl_b32 s13, s51, 6
    ds_read_b128 v[8:11], v6 offset:0
    ds_read_b128 v[12:15], v6 offset:10240
    ds_read_b128 v[16:19], v6 offset:20480
    s_add_u32 s24, s13, 2097152
    s_add_u32 s25, s13, 4194304
    s_waitcnt lgkmcnt(2)
    buffer_store_dwordx4 v[8:11], v7, s[20:23], s13 offen
    s_waitcnt lgkmcnt(1)
    buffer_store_dwordx4 v[12:15], v7, s[20:23], s24 offen
    s_waitcnt lgkmcnt(0)
    v_cmp_gt_u32 vcc, 260, v0
    s_and_saveexec_b64 s[32:33], vcc
    buffer_store_dwordx4 v[16:19], v7, s[20:23], s25 offen
    s_endpgm
L_k1wt_1:
    s_cmp_ge_u32 s2, 352
    s_cbranch_scc1 L_k1rl_3
    s_sub_u32 s12, s2, 256
    s_mul_i32 s13, s12, 43691
    s_lshr_b32 s13, s13, 18
    s_mul_i32 s14, s13, 6
    s_sub_u32 s14, s12, s14
    s_lshl_b32 s14, s14, 6
    v_add_u32 v3, s14, v1
    v_min_u32 v3, 320, v3
    s_waitcnt lgkmcnt(0)
    s_mov_b32 s16, s8
    s_and_b32 s17, s9, 0xffff
    s_mov_b32 s18, 0x141000
    s_mov_b32 s19, 0x00020000
    s_mov_b32 s20, s10
    s_and_b32 s21, s11, 0xffff
    s_mov_b32 s22, 0x141000
    s_mov_b32 s23, 0x00020000
    s_add_u32 s24, s6, 0xc00000
    s_addc_u32 s25, s7, 0
    s_and_b32 s25, s25, 0xffff
    s_mov_b32 s26, 0x282000
    s_mov_b32 s27, 0x00020000
    v_lshlrev_b32 v4, 1, v3
    s_lshl_b32 s28, s13, 5
    s_lshl_b32 s29, s3, 2
    s_add_u32 s28, s28, s29
    s_and_b32 s29, s28, 7
    s_lshl_b32 s29, s29, 6
    s_lshr_b32 s30, s28, 3
    s_and_b32 s30, s30, 7
    s_lshl_b32 s30, s30, 3
    s_lshr_b32 s31, s28, 6
    s_add_u32 s29, s29, s30
    s_add_u32 s29, s29, s31
    s_mul_i32 s29, s29, 642
    s_add_u32 s34, s29, 0
    buffer_load_ushort v8, v4, s[16:19], s34 offen
    buffer_load_ushort v24, v4, s[20:23], s34 offen
    s_add_u32 s34, s29, 328704
    buffer_load_ushort v9, v4, s[16:19], s34 offen
    buffer_load_ushort v25, v4, s[20:23], s34 offen
    s_add_u32 s34, s29, 657408
    buffer_load_ushort v10, v4, s[16:19], s34 offen
    buffer_load_ushort v26, v4, s[20:23], s34 offen
    s_add_u32 s34, s29, 986112
    buffer_load_ushort v11, v4, s[16:19], s34 offen
    buffer_load_ushort v27, v4, s[20:23], s34 offen
    s_add_u32 s34, s29, 41088
    buffer_load_ushort v12, v4, s[16:19], s34 offen
    buffer_load_ushort v28, v4, s[20:23], s34 offen
    s_add_u32 s34, s29, 369792
    buffer_load_ushort v13, v4, s[16:19], s34 offen
    buffer_load_ushort v29, v4, s[20:23], s34 offen
    s_add_u32 s34, s29, 698496
    buffer_load_ushort v14, v4, s[16:19], s34 offen
    buffer_load_ushort v30, v4, s[20:23], s34 offen
    s_add_u32 s34, s29, 1027200
    buffer_load_ushort v15, v4, s[16:19], s34 offen
    buffer_load_ushort v31, v4, s[20:23], s34 offen
    s_add_u32 s34, s29, 82176
    buffer_load_ushort v16, v4, s[16:19], s34 offen
    buffer_load_ushort v32, v4, s[20:23], s34 offen
    s_add_u32 s34, s29, 410880
    buffer_load_ushort v17, v4, s[16:19], s34 offen
    buffer_load_ushort v33, v4, s[20:23], s34 offen
    s_add_u32 s34, s29, 739584
    buffer_load_ushort v18, v4, s[16:19], s34 offen
    buffer_load_ushort v34, v4, s[20:23], s34 offen
    s_add_u32 s34, s29, 1068288
    buffer_load_ushort v19, v4, s[16:19], s34 offen
    buffer_load_ushort v35, v4, s[20:23], s34 offen
    s_add_u32 s34, s29, 123264
    buffer_load_ushort v20, v4, s[16:19], s34 offen
    buffer_load_ushort v36, v4, s[20:23], s34 offen
    s_add_u32 s34, s29, 451968
    buffer_load_ushort v21, v4, s[16:19], s34 offen
    buffer_load_ushort v37, v4, s[20:23], s34 offen
    s_add_u32 s34, s29, 780672
    buffer_load_ushort v22, v4, s[16:19], s34 offen
    buffer_load_ushort v38, v4, s[20:23], s34 offen
    s_add_u32 s34, s29, 1109376
    buffer_load_ushort v23, v4, s[16:19], s34 offen
    buffer_load_ushort v39, v4, s[20:23], s34 offen
    v_mul_u32_u24 v5, 528, v1
    s_lshl_b32 s30, s3, 6
    v_add_u32 v5, s30, v5
    s_waitcnt vmcnt(0)
    v_lshl_or_b32 v8, v24, 16, v8
    v_lshl_or_b32 v9, v25, 16, v9
    v_lshl_or_b32 v10, v26, 16, v10
    v_lshl_or_b32 v11, v27, 16, v11
    v_lshl_or_b32 v12, v28, 16, v12
    v_lshl_or_b32 v13, v29, 16, v13
    v_lshl_or_b32 v14, v30, 16, v14
    v_lshl_or_b32 v15, v31, 16, v15
    v_lshl_or_b32 v16, v32, 16, v16
    v_lshl_or_b32 v17, v33, 16, v17
    v_lshl_or_b32 v18, v34, 16, v18
    v_lshl_or_b32 v19, v35, 16, v19
    v_lshl_or_b32 v20, v36, 16, v20
    v_lshl_or_b32 v21, v37, 16, v21
    v_lshl_or_b32 v22, v38, 16, v22
    v_lshl_or_b32 v23, v39, 16, v23
    ds_write_b128 v5, v[8:11] offset:0
    ds_write_b128 v5, v[12:15] offset:16
    ds_write_b128 v5, v[16:19] offset:32
    ds_write_b128 v5, v[20:23] offset:48
    s_waitcnt lgkmcnt(0)
    s_barrier
    v_lshrrev_b32 v6, 5, v0
    v_and_b32 v7, 31, v0
    v_mul_u32_u24 v40, 528, v6
    v_lshl_add_u32 v40, v7, 4, v40
    v_add_u32 v41, s14, v6
    v_lshlrev_b32 v42, 13, v41
    v_lshl_add_u32 v42, v7, 4, v42
    s_lshl_b32 s28, s13, 9
    ds_read_b128 v[8:11], v40 offset:0
    ds_read_b128 v[12:15], v40 offset:8448
    ds_read_b128 v[16:19], v40 offset:16896
    ds_read_b128 v[20:23], v40 offset:25344
    s_waitcnt lgkmcnt(0)
    s_add_u32 s29, s28, 0
    buffer_store_dwordx4 v[8:11], v42, s[24:27], s29 offen
    s_add_u32 s29, s28, 131072
    buffer_store_dwordx4 v[12:15], v42, s[24:27], s29 offen
    s_add_u32 s29, s28, 262144
    buffer_store_dwordx4 v[16:19], v42, s[24:27], s29 offen
    s_add_u32 s29, s28, 393216
    buffer_store_dwordx4 v[20:23], v42, s[24:27], s29 offen
    s_endpgm
L_k1rl_3:
L_k1end_2:
    s_endpgm
.globl k2_kernel
.p2align 8
.type k2_kernel,@function
k2_kernel:
    s_load_dwordx2 s[6:7], s[0:1], 72
    s_cmp_ge_u32 s2, 321
    s_cbranch_scc1 L_k2x_4
    s_mov_b32 s40, 0x3f3504f3
    s_mov_b32 s41, 0x3f3504f3
    s_mov_b32 s42, 0x3e9e377a
    s_mov_b32 s43, 0x3e9e377a
    s_mov_b32 s44, 0xbf4f1bbd
    s_mov_b32 s45, 0xbf4f1bbd
    s_mov_b32 s46, 0x3f737871
    s_mov_b32 s47, 0x3f737871
    s_mov_b32 s48, 0x3f167918
    s_mov_b32 s49, 0x3f167918
    s_lshl_b32 s12, s2, 14
    s_lshl_b32 s13, s2, 13
    v_lshlrev_b32 v1, 3, v0
    v_lshlrev_b32 v2, 5, v0
    s_waitcnt lgkmcnt(0)
    s_add_u32 s16, s6, 0x0
    s_addc_u32 s17, s7, 0
    s_and_b32 s17, s17, 0xffff
    s_mov_b32 s18, 0x504000
    s_mov_b32 s19, 0x00020000
    s_add_u32 s20, s6, 0x600000
    s_addc_u32 s21, s7, 0
    s_and_b32 s21, s21, 0xffff
    s_mov_b32 s22, 0x504000
    s_mov_b32 s23, 0x00020000
    s_add_u32 s24, s6, 0xc00000
    s_addc_u32 s25, s7, 0
    s_and_b32 s25, s25, 0xffff
    s_mov_b32 s26, 0x282000
    s_mov_b32 s27, 0x00020000
    buffer_load_dwordx2 v[4:5], v1, s[16:19], s12 offen offset:0
    buffer_load_dwordx2 v[6:7], v1, s[16:19], s12 offen offset:2048
    s_add_u32 s30, s12, 4096
    s_add_u32 s31, s12, 6144
    s_add_u32 s32, s12, 8192
    s_add_u32 s33, s12, 10240
    s_add_u32 s34, s12, 12288
    s_add_u32 s35, s12, 14336
    buffer_load_dwordx2 v[8:9], v1, s[16:19], s30 offen
    buffer_load_dwordx2 v[10:11], v1, s[16:19], s31 offen
    buffer_load_dwordx2 v[12:13], v1, s[16:19], s32 offen
    buffer_load_dwordx2 v[14:15], v1, s[16:19], s33 offen
    buffer_load_dwordx2 v[16:17], v1, s[16:19], s34 offen
    buffer_load_dwordx2 v[18:19], v1, s[16:19], s35 offen
    buffer_load_dwordx4 v[92:95], v2, s[24:27], s13 offen
    buffer_load_dwordx4 v[96:99], v2, s[24:27], s13 offen offset:16
    v_cvt_f32_u32 v20, v0
    v_mul_f32 v20, 0xba000000, v20
    v_cos_f32 v40, v20
    v_sin_f32 v41, v20
    v_and_b32 v21, 31, v0
    v_cvt_f32_u32 v20, v21
    v_mul_f32 v20, 0xbb800000, v20
    v_cos_f32 v54, v20
    v_sin_f32 v55, v20
    v_and_b32 v22, 3, v0
    v_cvt_f32_u32 v20, v22
    v_mul_f32 v20, 0xbd000000, v20
    v_cos_f32 v68, v20
    v_sin_f32 v69, v20
    s_nop 0
    v_pk_mul_f32 v[24:25], v[40:41], v[40:41] op_sel:[0,0] op_sel_hi:[1,0]
    v_pk_fma_f32 v[42:43], v[40:41], v[40:41], v[24:25] op_sel:[1,1,0] op_sel_hi:[0,1,1] neg_lo:[0,1,0]
    v_pk_mul_f32 v[24:25], v[40:41], v[42:43] op_sel:[0,0] op_sel_hi:[1,0]
    v_pk_fma_f32 v[44:45], v[40:41], v[42:43], v[24:25] op_sel:[1,1,0] op_sel_hi:[0,1,1] neg_lo:[0,1,0]
    v_pk_mul_f32 v[24:25], v[42:43], v[42:43] op_sel:[0,0] op_sel_hi:[1,0]
    v_pk_fma_f32 v[46:47], v[42:43], v[42:43], v[24:25] op_sel:[1,1,0] op_sel_hi:[0,1,1] neg_lo:[0,1,0]
    v_pk_mul_f32 v[24:25], v[42:43], v[44:45] op_sel:[0,0] op_sel_hi:[1,0]
    v_pk_fma_f32 v[48:49], v[42:43], v[44:45], v[24:25] op_sel:[1,1,0] op_sel_hi:[0,1,1] neg_lo:[0,1,0]
    v_pk_mul_f32 v[24:25], v[44:45], v[44:45] op_sel:[0,0] op_sel_hi:[1,0]
    v_pk_fma_f32 v[50:51], v[44:45], v[44:45], v[24:25] op_sel:[1,1,0] op_sel_hi:[0,1,1] neg_lo:[0,1,0]
    v_pk_mul_f32 v[24:25], v[44:45], v[46:47] op_sel:[0,0] op_sel_hi:[1,0]
    v_pk_fma_f32 v[52:53], v[44:45], v[46:47], v[24:25] op_sel:[1,1,0] op_sel_hi:[0,1,1] neg_lo:[0,1,0]
    v_pk_mul_f32 v[24:25], v[54:55], v[54:55] op_sel:[0,0] op_sel_hi:[1,0]
    v_pk_fma_f32 v[56:57], v[54:55], v[54:55], v[24:25] op_sel:[1,1,0] op_sel_hi:[0,1,1] neg_lo:[0,1,0]
    v_pk_mul_f32 v[24:25], v[54:55], v[56:57] op_sel:[0,0] op_sel_hi:[1,0]
    v_pk_fma_f32 v[58:59], v[54:55], v[56:57], v[24:25] op_sel:[1,1,0] op_sel_hi:[0,1,1] neg_lo:[0,1,0]
    v_pk_mul_f32 v[24:25], v[56:57], v[56:57] op_sel:[0,0] op_sel_hi:[1,0]
    v_pk_fma_f32 v[60:61], v[56:57], v[56:57], v[24:25] op_sel:[1,1,0] op_sel_hi:[0,1,1] neg_lo:[0,1,0]
    v_pk_mul_f32 v[24:25], v[56:57], v[58:59] op_sel:[0,0] op_sel_hi:[1,0]
    v_pk_fma_f32 v[62:63], v[56:57], v[58:59], v[24:25] op_sel:[1,1,0] op_sel_hi:[0,1,1] neg_lo:[0,1,0]
    v_pk_mul_f32 v[24:25], v[58:59], v[58:59] op_sel:[0,0] op_sel_hi:[1,0]
    v_pk_fma_f32 v[64:65], v[58:59], v[58:59], v[24:25] op_sel:[1,1,0] op_sel_hi:[0,1,1] neg_lo:[0,1,0]
    v_pk_mul_f32 v[24:25], v[58:59], v[60:61] op_sel:[0,0] op_sel_hi:[1,0]
    v_pk_fma_f32 v[66:67], v[58:59], v[60:61], v[24:25] op_sel:[1,1,0] op_sel_hi:[0,1,1] neg_lo:[0,1,0]
    v_pk_mul_f32 v[24:25], v[68:69], v[68:69] op_sel:[0,0] op_sel_hi:[1,0]
    v_pk_fma_f32 v[70:71], v[68:69], v[68:69], v[24:25] op_sel:[1,1,0] op_sel_hi:[0,1,1] neg_lo:[0,1,0]
    v_pk_mul_f32 v[24:25], v[68:69], v[70:71] op_sel:[0,0] op_sel_hi:[1,0]
    v_pk_fma_f32 v[72:73], v[68:69], v[70:71], v[24:25] op_sel:[1,1,0] op_sel_hi:[0,1,1] neg_lo:[0,1,0]
    v_pk_mul_f32 v[24:25], v[70:71], v[70:71] op_sel:[0,0] op_sel_hi:[1,0]
    v_pk_fma_f32 v[74:75], v[70:71], v[70:71], v[24:25] op_sel:[1,1,0] op_sel_hi:[0,1,1] neg_lo:[0,1,0]
    v_pk_mul_f32 v[24:25], v[70:71], v[72:73] op_sel:[0,0] op_sel_hi:[1,0]
    v_pk_fma_f32 v[76:77], v[70:71], v[72:73], v[24:25] op_sel:[1,1,0] op_sel_hi:[0,1,1] neg_lo:[0,1,0]
    v_pk_mul_f32 v[24:25], v[72:73], v[72:73] op_sel:[0,0] op_sel_hi:[1,0]
    v_pk_fma_f32 v[78:79], v[72:73], v[72:73], v[24:25] op_sel:[1,1,0] op_sel_hi:[0,1,1] neg_lo:[0,1,0]
    v_pk_mul_f32 v[24:25], v[72:73], v[74:75] op_sel:[0,0] op_sel_hi:[1,0]
    v_pk_fma_f32 v[80:81], v[72:73], v[74:75], v[24:25] op_sel:[1,1,0] op_sel_hi:[0,1,1] neg_lo:[0,1,0]
    v_lshrrev_b32 v23, 5, v0
    v_mul_u32_u24 v82, 36, v23
    v_add_u32 v82, v82, v21
    v_lshlrev_b32 v82, 3, v82
    v_mul_u32_u24 v83, 288, v23
    v_add_u32 v84, v83, v22
    v_add_u32 v83, v83, v21
    v_lshlrev_b32 v83, 3, v83
    v_bfe_u32 v24, v0, 2, 3
    v_mul_u32_u24 v24, 36, v24
    v_add_u32 v84, v84, v24
    v_mul_u32_u24 v85, 7, v22
    v_add_u32 v85, v85, v84
    v_lshlrev_b32 v84, 3, v84
    v_lshlrev_b32 v85, 3, v85
    s_waitcnt vmcnt(2)
    v_pk_add_f32 v[38:39], v[4:5], v[12:13] neg_lo:[0,1] neg_hi:[0,1]
    v_pk_add_f32 v[4:5], v[4:5], v[12:13]
    v_pk_add_f32 v[12:13], v[6:7], v[14:15] neg_lo:[0,1] neg_hi:[0,1]
    v_pk_add_f32 v[6:7], v[6:7], v[14:15]
    v_pk_add_f32 v[14:15], v[8:9], v[16:17] neg_lo:[0,1] neg_hi:[0,1]
    v_pk_add_f32 v[8:9], v[8:9], v[16:17]
    v_pk_add_f32 v[16:17], v[10:11], v[18:19] neg_lo:[0,1] neg_hi:[0,1]
    v_pk_add_f32 v[10:11], v[10:11], v[18:19]
    v_pk_add_f32 v[18:19], v[4:5], v[8:9] neg_lo:[0,1] neg_hi:[0,1]
    v_pk_add_f32 v[4:5], v[4:5], v[8:9]
    v_pk_add_f32 v[8:9], v[6:7], v[10:11] neg_lo:[0,1] neg_hi:[0,1]
    v_pk_add_f32 v[6:7], v[6:7], v[10:11]
    v_pk_add_f32 v[10:11], v[4:5], v[6:7] neg_lo:[0,1] neg_hi:[0,1]
    v_pk_add_f32 v[4:5], v[4:5], v[6:7]
    v_pk_add_f32 v[6:7], v[18:19], v[8:9] op_sel:[0,1] op_sel_hi:[1,0] neg_lo:[0,1]
    v_pk_add_f32 v[18:19], v[18:19], v[8:9] op_sel:[0,1] op_sel_hi:[1,0] neg_hi:[0,1]
    v_pk_add_f32 v[12:13], v[12:13], v[12:13] op_sel:[0,1] op_sel_hi:[1,0] neg_hi:[0,1]
    v_pk_add_f32 v[16:17], v[16:17], v[16:17] op_sel:[0,1] op_sel_hi:[1,0] neg_lo:[0,1]
    v_pk_add_f32 v[8:9], v[38:39], v[14:15] op_sel:[0,1] op_sel_hi:[1,0] neg_lo:[0,1]
    v_pk_add_f32 v[38:39], v[38:39], v[14:15] op_sel:[0,1] op_sel_hi:[1,0] neg_hi:[0,1]
    v_pk_add_f32 v[14:15], v[12:13], v[16:17] neg_lo:[0,1] neg_hi:[0,1]
    v_pk_add_f32 v[12:13], v[12:13], v[16:17]
    v_pk_fma_f32 v[16:17], v[14:15], s[40:41], v[38:39] op_sel_hi:[1,0,1] neg_lo:[1,0,0] neg_hi:[1,0,0]
    v_pk_fma_f32 v[38:39], v[14:15], s[40:41], v[38:39] op_sel_hi:[1,0,1]
    v_pk_fma_f32 v[14:15], v[12:13], s[40:41], v[8:9] op_sel:[1,0,0] op_sel_hi:[0,0,1] neg_lo:[1,0,0]
    v_pk_fma_f32 v[8:9], v[12:13], s[40:41], v[8:9] op_sel:[1,0,0] op_sel_hi:[0,0,1] neg_hi:[1,0,0]
    v_pk_mul_f32 v[12:13], v[38:39], v[40:41] op_sel:[0,0] op_sel_hi:[1,0]
    v_pk_fma_f32 v[38:39], v[38:39], v[40:41], v[12:13] op_sel:[1,1,0] op_sel_hi:[0,1,1] neg_lo:[0,1,0]
    v_pk_mul_f32 v[12:13], v[18:19], v[42:43] op_sel:[0,0] op_sel_hi:[1,0]
    v_pk_fma_f32 v[18:19], v[18:19], v[42:43], v[12:13] op_sel:[1,1,0] op_sel_hi:[0,1,1] neg_lo:[0,1,0]
    v_pk_mul_f32 v[12:13], v[8:9], v[44:45] op_sel:[0,0] op_sel_hi:[1,0]
    v_pk_fma_f32 v[8:9], v[8:9], v[44:45], v[12:13] op_sel:[1,1,0] op_sel_hi:[0,1,1] neg_lo:[0,1,0]
    v_pk_mul_f32 v[12:13], v[10:11], v[46:47] op_sel:[0,0] op_sel_hi:[1,0]
    v_pk_fma_f32 v[10:11], v[10:11], v[46:47], v[12:13] op_sel:[1,1,0] op_sel_hi:[0,1,1] neg_lo:[0,1,0]
    v_pk_mul_f32 v[12:13], v[16:17], v[48:49] op_sel:[0,0] op_sel_hi:[1,0]
    v_pk_fma_f32 v[16:17], v[16:17], v[48:49], v[12:13] op_sel:[1,1,0] op_sel_hi:[0,1,1] neg_lo:[0,1,0]
    v_pk_mul_f32 v[12:13], v[6:7], v[50:51] op_sel:[0,0] op_sel_hi:[1,0]
    v_pk_fma_f32 v[6:7], v[6:7], v[50:51], v[12:13] op_sel:[1,1,0] op_sel_hi:[0,1,1] neg_lo:[0,1,0]
    v_pk_mul_f32 v[12:13], v[14:15], v[52:53] op_sel:[0,0] op_sel_hi:[1,0]
    v_pk_fma_f32 v[14:15], v[14:15], v[52:53], v[12:13] op_sel:[1,1,0] op_sel_hi:[0,1,1] neg_lo:[0,1,0]
    ds_write_b64 v82, v[4:5] offset:0
    ds_write_b64 v82, v[38:39] offset:2304
    ds_write_b64 v82, v[18:19] offset:4608
    ds_write_b64 v82, v[8:9] offset:6912
    ds_write_b64 v82, v[10:11] offset:9216
    ds_write_b64 v82, v[16:17] offset:11520
    ds_write_b64 v82, v[6:7] offset:13824
    ds_write_b64 v82, v[14:15] offset:16128
    s_waitcnt lgkmcnt(0)
    s_barrier
    ds_read_b64 v[4:5], v83 offset:0
    ds_read_b64 v[38:39], v83 offset:288
    ds_read_b64 v[18:19], v83 offset:576
    ds_read_b64 v[8:9], v83 offset:864
    ds_read_b64 v[10:11], v83 offset:1152
    ds_read_b64 v[16:17], v83 offset:1440
    ds_read_b64 v[6:7], v83 offset:1728
    ds_read_b64 v[14:15], v83 offset:2016
    s_waitcnt lgkmcnt(0)
    v_pk_add_f32 v[12:13], v[4:5], v[10:11] neg_lo:[0,1] neg_hi:[0,1]
    v_pk_add_f32 v[4:5], v[4:5], v[10:11]
    v_pk_add_f32 v[10:11], v[38:39], v[16:17] neg_lo:[0,1] neg_hi:[0,1]
    v_pk_add_f32 v[38:39], v[38:39], v[16:17]
    v_pk_add_f32 v[16:17], v[18:19], v[6:7] neg_lo:[0,1] neg_hi:[0,1]
    v_pk_add_f32 v[18:19], v[18:19], v[6:7]
    v_pk_add_f32 v[6:7], v[8:9], v[14:15] neg_lo:[0,1] neg_hi:[0,1]
    v_pk_add_f32 v[8:9], v[8:9], v[14:15]
    v_pk_add_f32 v[14:15], v[4:5], v[18:19] neg_lo:[0,1] neg_hi:[0,1]
    v_pk_add_f32 v[4:5], v[4:5], v[18:19]
    v_pk_add_f32 v[18:19], v[38:39], v[8:9] neg_lo:[0,1] neg_hi:[0,1]
    v_pk_add_f32 v[38:39], v[38:39], v[8:9]
    v_pk_add_f32 v[8:9], v[4:5], v[38:39] neg_lo:[0,1] neg_hi:[0,1]
    v_pk_add_f32 v[4:5], v[4:5], v[38:39]
    v_pk_add_f32 v[38:39], v[14:15], v[18:19] op_sel:[0,1] op_sel_hi:[1,0] neg_lo:[0,1]
    v_pk_add_f32 v[14:15], v[14:15], v[18:19] op_sel:[0,1] op_sel_hi:[1,0] neg_hi:[0,1]
    v_pk_add_f32 v[10:11], v[10:11], v[10:11] op_sel:[0,1] op_sel_hi:[1,0] neg_hi:[0,1]
    v_pk_add_f32 v[6:7], v[6:7], v[6:7] op_sel:[0,1] op_sel_hi:[1,0] neg_lo:[0,1]
    v_pk_add_f32 v[18:19], v[12:13], v[16:17] op_sel:[0,1] op_sel_hi:[1,0] neg_lo:[0,1]
    v_pk_add_f32 v[12:13], v[12:13], v[16:17] op_sel:[0,1] op_sel_hi:[1,0] neg_hi:[0,1]
    v_pk_add_f32 v[16:17], v[10:11], v[6:7] neg_lo:[0,1] neg_hi:[0,1]
    v_pk_add_f32 v[10:11], v[10:11], v[6:7]
    v_pk_fma_f32 v[6:7], v[16:17], s[40:41], v[12:13] op_sel_hi:[1,0,1] neg_lo:[1,0,0] neg_hi:[1,0,0]
    v_pk_fma_f32 v[12:13], v[16:17], s[40:41], v[12:13] op_sel_hi:[1,0,1]
    v_pk_fma_f32 v[16:17], v[10:11], s[40:41], v[18:19] op_sel:[1,0,0] op_sel_hi:[0,0,1] neg_lo:[1,0,0]
    v_pk_fma_f32 v[18:19], v[10:11], s[40:41], v[18:19] op_sel:[1,0,0] op_sel_hi:[0,0,1] neg_hi:[1,0,0]
    v_pk_mul_f32 v[10:11], v[12:13], v[54:55] op_sel:[0,0] op_sel_hi:[1,0]
    v_pk_fma_f32 v[12:13], v[12:13], v[54:55], v[10:11] op_sel:[1,1,0] op_sel_hi:[0,1,1] neg_lo:[0,1,0]
    v_pk_mul_f32 v[10:11], v[14:15], v[56:57] op_sel:[0,0] op_sel_hi:[1,0]
    v_pk_fma_f32 v[14:15], v[14:15], v[56:57], v[10:11] op_sel:[1,1,0] op_sel_hi:[0,1,1] neg_lo:[0,1,0]
    v_pk_mul_f32 v[10:11], v[18:19], v[58:59] op_sel:[0,0] op_sel_hi:[1,0]
    v_pk_fma_f32 v[18:19], v[18:19], v[58:59], v[10:11] op_sel:[1,1,0] op_sel_hi:[0,1,1] neg_lo:[0,1,0]
    v_pk_mul_f32 v[10:11], v[8:9], v[60:61] op_sel:[0,0] op_sel_hi:[1,0]
    v_pk_fma_f32 v[8:9], v[8:9], v[60:61], v[10:11] op_sel:[1,1,0] op_sel_hi:[0,1,1] neg_lo:[0,1,0]
    v_pk_mul_f32 v[10:11], v[6:7], v[62:63] op_sel:[0,0] op_sel_hi:[1,0]
    v_pk_fma_f32 v[6:7], v[6:7], v[62:63], v[10:11] op_sel:[1,1,0] op_sel_hi:[0,1,1] neg_lo:[0,1,0]
    v_pk_mul_f32 v[10:11], v[38:39], v[64:65] op_sel:[0,0] op_sel_hi:[1,0]
    v_pk_fma_f32 v[38:39], v[38:39], v[64:65], v[10:11] op_sel:[1,1,0] op_sel_hi:[0,1,1] neg_lo:[0,1,0]
    v_pk_mul_f32 v[10:11], v[16:17], v[66:67] op_sel:[0,0] op_sel_hi:[1,0]
    v_pk_fma_f32 v[16:17], v[16:17], v[66:67], v[10:11] op_sel:[1,1,0] op_sel_hi:[0,1,1] neg_lo:[0,1,0]
    ds_write_b64 v83, v[4:5] offset:18432
    ds_write_b64 v83, v[12:13] offset:18720
    ds_write_b64 v83, v[14:15] offset:19008
    ds_write_b64 v83, v[18:19] offset:19296
    ds_write_b64 v83, v[8:9] offset:19584
    ds_write_b64 v83, v[6:7] offset:19872
    ds_write_b64 v83, v[38:39] offset:20160
    ds_write_b64 v83, v[16:17] offset:20448
    s_waitcnt lgkmcnt(0)
    ds_read_b64 v[4:5], v84 offset:18432
    ds_read_b64 v[12:13], v84 offset:18464
    ds_read_b64 v[14:15], v84 offset:18496
    ds_read_b64 v[18:19], v84 offset:18528
    ds_read_b64 v[8:9], v84 offset:18560
    ds_read_b64 v[6:7], v84 offset:18592
    ds_read_b64 v[38:39], v84 offset:18624
    ds_read_b64 v[16:17], v84 offset:18656
    s_waitcnt lgkmcnt(0)
    v_pk_add_f32 v[10:11], v[4:5], v[8:9] neg_lo:[0,1] neg_hi:[0,1]
    v_pk_add_f32 v[4:5], v[4:5], v[8:9]
    v_pk_add_f32 v[8:9], v[12:13], v[6:7] neg_lo:[0,1] neg_hi:[0,1]
    v_pk_add_f32 v[12:13], v[12:13], v[6:7]
    v_pk_add_f32 v[6:7], v[14:15], v[38:39] neg_lo:[0,1] neg_hi:[0,1]
    v_pk_add_f32 v[14:15], v[14:15], v[38:39]
    v_pk_add_f32 v[38:39], v[18:19], v[16:17] neg_lo:[0,1] neg_hi:[0,1]
    v_pk_add_f32 v[18:19], v[18:19], v[16:17]
    v_pk_add_f32 v[16:17], v[4:5], v[14:15] neg_lo:[0,1] neg_hi:[0,1]
    v_pk_add_f32 v[4:5], v[4:5], v[14:15]
    v_pk_add_f32 v[14:15], v[12:13], v[18:19] neg_lo:[0,1] neg_hi:[0,1]
    v_pk_add_f32 v[12:13], v[12:13], v[18:19]
    v_pk_add_f32 v[18:19], v[4:5], v[12:13] neg_lo:[0,1] neg_hi:[0,1]
    v_pk_add_f32 v[4:5], v[4:5], v[12:13]
    v_pk_add_f32 v[12:13], v[16:17], v[14:15] op_sel:[0,1] op_sel_hi:[1,0] neg_lo:[0,1]
    v_pk_add_f32 v[16:17], v[16:17], v[14:15] op_sel:[0,1] op_sel_hi:[1,0] neg_hi:[0,1]
    v_pk_add_f32 v[8:9], v[8:9], v[8:9] op_sel:[0,1] op_sel_hi:[1,0] neg_hi:[0,1]
    v_pk_add_f32 v[38:39], v[38:39], v[38:39] op_sel:[0,1] op_sel_hi:[1,0] neg_lo:[0,1]
    v_pk_add_f32 v[14:15], v[10:11], v[6:7] op_sel:[0,1] op_sel_hi:[1,0] neg_lo:[0,1]
    v_pk_add_f32 v[10:11], v[10:11], v[6:7] op_sel:[0,1] op_sel_hi:[1,0] neg_hi:[0,1]
    v_pk_add_f32 v[6:7], v[8:9], v[38:39] neg_lo:[0,1] neg_hi:[0,1]
    v_pk_add_f32 v[8:9], v[8:9], v[38:39]
    v_pk_fma_f32 v[38:39], v[6:7], s[40:41], v[10:11] op_sel_hi:[1,0,1] neg_lo:[1,0,0] neg_hi:[1,0,0]
    v_pk_fma_f32 v[10:11], v[6:7], s[40:41], v[10:11] op_sel_hi:[1,0,1]
    v_pk_fma_f32 v[6:7], v[8:9], s[40:41], v[14:15] op_sel:[1,0,0] op_sel_hi:[0,0,1] neg_lo:[1,0,0]
    v_pk_fma_f32 v[14:15], v[8:9], s[40:41], v[14:15] op_sel:[1,0,0] op_sel_hi:[0,0,1] neg_hi:[1,0,0]
    v_pk_mul_f32 v[8:9], v[10:11], v[68:69] op_sel:[0,0] op_sel_hi:[1,0]
    v_pk_fma_f32 v[10:11], v[10:11], v[68:69], v[8:9] op_sel:[1,1,0] op_sel_hi:[0,1,1] neg_lo:[0,1,0]
    v_pk_mul_f32 v[8:9], v[16:17], v[70:71] op_sel:[0,0] op_sel_hi:[1,0]
    v_pk_fma_f32 v[16:17], v[16:17], v[70:71], v[8:9] op_sel:[1,1,0] op_sel_hi:[0,1,1] neg_lo:[0,1,0]
    v_pk_mul_f32 v[8:9], v[14:15], v[72:73] op_sel:[0,0] op_sel_hi:[1,0]
    v_pk_fma_f32 v[14:15], v[14:15], v[72:73], v[8:9] op_sel:[1,1,0] op_sel_hi:[0,1,1] neg_lo:[0,1,0]
    v_pk_mul_f32 v[8:9], v[18:19], v[74:75] op_sel:[0,0] op_sel_hi:[1,0]
    v_pk_fma_f32 v[18:19], v[18:19], v[74:75], v[8:9] op_sel:[1,1,0] op_sel_hi:[0,1,1] neg_lo:[0,1,0]
    v_pk_mul_f32 v[8:9], v[38:39], v[76:77] op_sel:[0,0] op_sel_hi:[1,0]
    v_pk_fma_f32 v[38:39], v[38:39], v[76:77], v[8:9] op_sel:[1,1,0] op_sel_hi:[0,1,1] neg_lo:[0,1,0]
    v_pk_mul_f32 v[8:9], v[12:13], v[78:79] op_sel:[0,0] op_sel_hi:[1,0]
    v_pk_fma_f32 v[12:13], v[12:13], v[78:79], v[8:9] op_sel:[1,1,0] op_sel_hi:[0,1,1] neg_lo:[0,1,0]
    v_pk_mul_f32 v[8:9], v[6:7], v[80:81] op_sel:[0,0] op_sel_hi:[1,0]
    v_pk_fma_f32 v[6:7], v[6:7], v[80:81], v[8:9] op_sel:[1,1,0] op_sel_hi:[0,1,1] neg_lo:[0,1,0]
    ds_write_b64 v84, v[4:5] offset:0
    ds_write_b64 v84, v[10:11] offset:32
    ds_write_b64 v84, v[16:17] offset:64
    ds_write_b64 v84, v[14:15] offset:96
    ds_write_b64 v84, v[18:19] offset:128
    ds_write_b64 v84, v[38:39] offset:160
    ds_write_b64 v84, v[12:13] offset:192
    ds_write_b64 v84, v[6:7] offset:224
    s_waitcnt lgkmcnt(0)
    ds_read_b64 v[4:5], v85 offset:0
    ds_read_b64 v[10:11], v85 offset:8
    ds_read_b64 v[16:17], v85 offset:16
    ds_read_b64 v[14:15], v85 offset:24
    ds_read_b64 v[18:19], v85 offset:32
    ds_read_b64 v[38:39], v85 offset:40
    ds_read_b64 v[12:13], v85 offset:48
    ds_read_b64 v[6:7], v85 offset:56
    s_waitcnt lgkmcnt(0)
    v_pk_add_f32 v[8:9], v[4:5], v[16:17] neg_lo:[0,1] neg_hi:[0,1]
    v_pk_add_f32 v[4:5], v[4:5], v[16:17]
    v_pk_add_f32 v[16:17], v[10:11], v[14:15] neg_lo:[0,1] neg_hi:[0,1]
    v_pk_add_f32 v[10:11], v[10:11], v[14:15]
    v_pk_add_f32 v[14:15], v[4:5], v[10:11] neg_lo:[0,1] neg_hi:[0,1]
    v_pk_add_f32 v[4:5], v[4:5], v[10:11]
    v_pk_add_f32 v[10:11], v[8:9], v[16:17] op_sel:[0,1] op_sel_hi:[1,0] neg_lo:[0,1]
    v_pk_add_f32 v[8:9], v[8:9], v[16:17] op_sel:[0,1] op_sel_hi:[1,0] neg_hi:[0,1]
    v_pk_add_f32 v[16:17], v[18:19], v[12:13] neg_lo:[0,1] neg_hi:[0,1]
    v_pk_add_f32 v[18:19], v[18:19], v[12:13]
    v_pk_add_f32 v[12:13], v[38:39], v[6:7] neg_lo:[0,1] neg_hi:[0,1]
    v_pk_add_f32 v[38:39], v[38:39], v[6:7]
    v_pk_add_f32 v[6:7], v[18:19], v[38:39] neg_lo:[0,1] neg_hi:[0,1]
    v_pk_add_f32 v[18:19], v[18:19], v[38:39]
    v_pk_add_f32 v[38:39], v[16:17], v[12:13] op_sel:[0,1] op_sel_hi:[1,0] neg_lo:[0,1]
    v_pk_add_f32 v[16:17], v[16:17], v[12:13] op_sel:[0,1] op_sel_hi:[1,0] neg_hi:[0,1]
    s_waitcnt vmcnt(0)
    v_lshlrev_b32 v36, 16, v92
    v_and_b32 v37, 0xffff0000, v92
    v_pk_mul_f32 v[12:13], v[4:5], v[36:37] op_sel:[0,0] op_sel_hi:[1,0]
    v_pk_fma_f32 v[4:5], v[4:5], v[36:37], v[12:13] op_sel:[1,1,0] op_sel_hi:[0,1,1] neg_lo:[0,1,0]
    v_lshlrev_b32 v36, 16, v93
    v_and_b32 v37, 0xffff0000, v93
    v_pk_mul_f32 v[12:13], v[8:9], v[36:37] op_sel:[0,0] op_sel_hi:[1,0]
    v_pk_fma_f32 v[8:9], v[8:9], v[36:37], v[12:13] op_sel:[1,1,0] op_sel_hi:[0,1,1] neg_lo:[0,1,0]
    v_lshlrev_b32 v36, 16, v94
    v_and_b32 v37, 0xffff0000, v94
    v_pk_mul_f32 v[12:13], v[14:15], v[36:37] op_sel:[0,0] op_sel_hi:[1,0]
    v_pk_fma_f32 v[14:15], v[14:15], v[36:37], v[12:13] op_sel:[1,1,0] op_sel_hi:[0,1,1] neg_lo:[0,1,0]
    v_lshlrev_b32 v36, 16, v95
    v_and_b32 v37, 0xffff0000, v95
    v_pk_mul_f32 v[12:13], v[10:11], v[36:37] op_sel:[0,0] op_sel_hi:[1,0]
    v_pk_fma_f32 v[10:11], v[10:11], v[36:37], v[12:13] op_sel:[1,1,0] op_sel_hi:[0,1,1] neg_lo:[0,1,0]
    v_lshlrev_b32 v36, 16, v96
    v_and_b32 v37, 0xffff0000, v96
    v_pk_mul_f32 v[12:13], v[18:19], v[36:37] op_sel:[0,0] op_sel_hi:[1,0]
    v_pk_fma_f32 v[18:19], v[18:19], v[36:37], v[12:13] op_sel:[1,1,0] op_sel_hi:[0,1,1] neg_lo:[0,1,0]
    v_lshlrev_b32 v36, 16, v97
    v_and_b32 v37, 0xffff0000, v97
    v_pk_mul_f32 v[12:13], v[16:17], v[36:37] op_sel:[0,0] op_sel_hi:[1,0]
    v_pk_fma_f32 v[16:17], v[16:17], v[36:37], v[12:13] op_sel:[1,1,0] op_sel_hi:[0,1,1] neg_lo:[0,1,0]
    v_lshlrev_b32 v36, 16, v98
    v_and_b32 v37, 0xffff0000, v98
    v_pk_mul_f32 v[12:13], v[6:7], v[36:37] op_sel:[0,0] op_sel_hi:[1,0]
    v_pk_fma_f32 v[6:7], v[6:7], v[36:37], v[12:13] op_sel:[1,1,0] op_sel_hi:[0,1,1] neg_lo:[0,1,0]
    v_lshlrev_b32 v36, 16, v99
    v_and_b32 v37, 0xffff0000, v99
    v_pk_mul_f32 v[12:13], v[38:39], v[36:37] op_sel:[0,0] op_sel_hi:[1,0]
    v_pk_fma_f32 v[38:39], v[38:39], v[36:37], v[12:13] op_sel:[1,1,0] op_sel_hi:[0,1,1] neg_lo:[0,1,0]
    v_pk_add_f32 v[36:37], v[4:5], v[14:15] neg_lo:[0,1] neg_hi:[0,1]
    v_pk_add_f32 v[4:5], v[4:5], v[14:15]
    v_pk_add_f32 v[14:15], v[8:9], v[10:11] neg_lo:[0,1] neg_hi:[0,1]
    v_pk_add_f32 v[8:9], v[8:9], v[10:11]
    v_pk_add_f32 v[10:11], v[4:5], v[8:9] neg_lo:[0,1] neg_hi:[0,1]
    v_pk_add_f32 v[4:5], v[4:5], v[8:9]
    v_pk_add_f32 v[8:9], v[36:37], v[14:15] op_sel:[0,1] op_sel_hi:[1,0] neg_hi:[0,1]
    v_pk_add_f32 v[36:37], v[36:37], v[14:15] op_sel:[0,1] op_sel_hi:[1,0] neg_lo:[0,1]
    v_pk_add_f32 v[14:15], v[18:19], v[6:7] neg_lo:[0,1] neg_hi:[0,1]
    v_pk_add_f32 v[18:19], v[18:19], v[6:7]
    v_pk_add_f32 v[6:7], v[16:17], v[38:39] neg_lo:[0,1] neg_hi:[0,1]
    v_pk_add_f32 v[16:17], v[16:17], v[38:39]
    v_pk_add_f32 v[38:39], v[18:19], v[16:17] neg_lo:[0,1] neg_hi:[0,1]
    v_pk_add_f32 v[18:19], v[18:19], v[16:17]
    v_pk_add_f32 v[16:17], v[14:15], v[6:7] op_sel:[0,1] op_sel_hi:[1,0] neg_hi:[0,1]
    v_pk_add_f32 v[14:15], v[14:15], v[6:7] op_sel:[0,1] op_sel_hi:[1,0] neg_lo:[0,1]
    ds_write_b64 v85, v[4:5] offset:18432
    ds_write_b64 v85, v[36:37] offset:18440
    ds_write_b64 v85, v[10:11] offset:18448
    ds_write_b64 v85, v[8:9] offset:18456
    ds_write_b64 v85, v[18:19] offset:18464
    ds_write_b64 v85, v[14:15] offset:18472
    ds_write_b64 v85, v[38:39] offset:18480
    ds_write_b64 v85, v[16:17] offset:18488
    s_waitcnt lgkmcnt(0)
    ds_read_b64 v[4:5], v84 offset:18432
    ds_read_b64 v[36:37], v84 offset:18464
    ds_read_b64 v[10:11], v84 offset:18496
    ds_read_b64 v[8:9], v84 offset:18528
    ds_read_b64 v[18:19], v84 offset:18560
    ds_read_b64 v[14:15], v84 offset:18592
    ds_read_b64 v[38:39], v84 offset:18624
    ds_read_b64 v[16:17], v84 offset:18656
    s_waitcnt lgkmcnt(0)
    v_pk_mul_f32 v[6:7], v[36:37], v[68:69] op_sel:[0,0] op_sel_hi:[1,0]
    v_pk_fma_f32 v[36:37], v[36:37], v[68:69], v[6:7] op_sel:[1,1,0] op_sel_hi:[0,1,1] neg_hi:[0,1,0]
    v_pk_mul_f32 v[6:7], v[10:11], v[70:71] op_sel:[0,0] op_sel_hi:[1,0]
    v_pk_fma_f32 v[10:11], v[10:11], v[70:71], v[6:7] op_sel:[1,1,0] op_sel_hi:[0,1,1] neg_hi:[0,1,0]
    v_pk_mul_f32 v[6:7], v[8:9], v[72:73] op_sel:[0,0] op_sel_hi:[1,0]
    v_pk_fma_f32 v[8:9], v[8:9], v[72:73], v[6:7] op_sel:[1,1,0] op_sel_hi:[0,1,1] neg_hi:[0,1,0]
    v_pk_mul_f32 v[6:7], v[18:19], v[74:75] op_sel:[0,0] op_sel_hi:[1,0]
    v_pk_fma_f32 v[18:19], v[18:19], v[74:75], v[6:7] op_sel:[1,1,0] op_sel_hi:[0,1,1] neg_hi:[0,1,0]
    v_pk_mul_f32 v[6:7], v[14:15], v[76:77] op_sel:[0,0] op_sel_hi:[1,0]
    v_pk_fma_f32 v[14:15], v[14:15], v[76:77], v[6:7] op_sel:[1,1,0] op_sel_hi:[0,1,1] neg_hi:[0,1,0]
    v_pk_mul_f32 v[6:7], v[38:39], v[78:79] op_sel:[0,0] op_sel_hi:[1,0]
    v_pk_fma_f32 v[38:39], v[38:39], v[78:79], v[6:7] op_sel:[1,1,0] op_sel_hi:[0,1,1] neg_hi:[0,1,0]
    v_pk_mul_f32 v[6:7], v[16:17], v[80:81] op_sel:[0,0] op_sel_hi:[1,0]
    v_pk_fma_f32 v[16:17], v[16:17], v[80:81], v[6:7] op_sel:[1,1,0] op_sel_hi:[0,1,1] neg_hi:[0,1,0]
    v_pk_add_f32 v[6:7], v[4:5], v[18:19] neg_lo:[0,1] neg_hi:[0,1]
    v_pk_add_f32 v[4:5], v[4:5], v[18:19]
    v_pk_add_f32 v[18:19], v[36:37], v[14:15] neg_lo:[0,1] neg_hi:[0,1]
    v_pk_add_f32 v[36:37], v[36:37], v[14:15]
    v_pk_add_f32 v[14:15], v[10:11], v[38:39] neg_lo:[0,1] neg_hi:[0,1]
    v_pk_add_f32 v[10:11], v[10:11], v[38:39]
    v_pk_add_f32 v[38:39], v[8:9], v[16:17] neg_lo:[0,1] neg_hi:[0,1]
    v_pk_add_f32 v[8:9], v[8:9], v[16:17]
    v_pk_add_f32 v[16:17], v[4:5], v[10:11] neg_lo:[0,1] neg_hi:[0,1]
    v_pk_add_f32 v[4:5], v[4:5], v[10:11]
    v_pk_add_f32 v[10:11], v[36:37], v[8:9] neg_lo:[0,1] neg_hi:[0,1]
    v_pk_add_f32 v[36:37], v[36:37], v[8:9]
    v_pk_add_f32 v[8:9], v[4:5], v[36:37] neg_lo:[0,1] neg_hi:[0,1]
    v_pk_add_f32 v[4:5], v[4:5], v[36:37]
    v_pk_add_f32 v[36:37], v[16:17], v[10:11] op_sel:[0,1] op_sel_hi:[1,0] neg_hi:[0,1]
    v_pk_add_f32 v[16:17], v[16:17], v[10:11] op_sel:[0,1] op_sel_hi:[1,0] neg_lo:[0,1]
    v_pk_add_f32 v[18:19], v[18:19], v[18:19] op_sel:[0,1] op_sel_hi:[1,0] neg_lo:[0,1]
    v_pk_add_f32 v[38:39], v[38:39], v[38:39] op_sel:[0,1] op_sel_hi:[1,0] neg_hi:[0,1]
    v_pk_add_f32 v[10:11], v[6:7], v[14:15] op_sel:[0,1] op_sel_hi:[1,0] neg_hi:[0,1]
    v_pk_add_f32 v[6:7], v[6:7], v[14:15] op_sel:[0,1] op_sel_hi:[1,0] neg_lo:[0,1]
    v_pk_add_f32 v[14:15], v[18:19], v[38:39] neg_lo:[0,1] neg_hi:[0,1]
    v_pk_add_f32 v[18:19], v[18:19], v[38:39]
    v_pk_fma_f32 v[38:39], v[14:15], s[40:41], v[6:7] op_sel_hi:[1,0,1] neg_lo:[1,0,0] neg_hi:[1,0,0]
    v_pk_fma_f32 v[6:7], v[14:15], s[40:41], v[6:7] op_sel_hi:[1,0,1]
    v_pk_fma_f32 v[14:15], v[18:19], s[40:41], v[10:11] op_sel:[1,0,0] op_sel_hi:[0,0,1] neg_hi:[1,0,0]
    v_pk_fma_f32 v[10:11], v[18:19], s[40:41], v[10:11] op_sel:[1,0,0] op_sel_hi:[0,0,1] neg_lo:[1,0,0]
    ds_write_b64 v84, v[4:5] offset:0
    ds_write_b64 v84, v[6:7] offset:32
    ds_write_b64 v84, v[16:17] offset:64
    ds_write_b64 v84, v[10:11] offset:96
    ds_write_b64 v84, v[8:9] offset:128
    ds_write_b64 v84, v[38:39] offset:160
    ds_write_b64 v84, v[36:37] offset:192
    ds_write_b64 v84, v[14:15] offset:224
    s_waitcnt lgkmcnt(0)
    ds_read_b64 v[4:5], v83 offset:0
    ds_read_b64 v[6:7], v83 offset:288
    ds_read_b64 v[16:17], v83 offset:576
    ds_read_b64 v[10:11], v83 offset:864
    ds_read_b64 v[8:9], v83 offset:1152
    ds_read_b64 v[38:39], v83 offset:1440
    ds_read_b64 v[36:37], v83 offset:1728
    ds_read_b64 v[14:15], v83 offset:2016
    s_waitcnt lgkmcnt(0)
    v_pk_mul_f32 v[18:19], v[6:7], v[54:55] op_sel:[0,0] op_sel_hi:[1,0]
    v_pk_fma_f32 v[6:7], v[6:7], v[54:55], v[18:19] op_sel:[1,1,0] op_sel_hi:[0,1,1] neg_hi:[0,1,0]
    v_pk_mul_f32 v[18:19], v[16:17], v[56:57] op_sel:[0,0] op_sel_hi:[1,0]
    v_pk_fma_f32 v[16:17], v[16:17], v[56:57], v[18:19] op_sel:[1,1,0] op_sel_hi:[0,1,1] neg_hi:[0,1,0]
    v_pk_mul_f32 v[18:19], v[10:11], v[58:59] op_sel:[0,0] op_sel_hi:[1,0]
    v_pk_fma_f32 v[10:11], v[10:11], v[58:59], v[18:19] op_sel:[1,1,0] op_sel_hi:[0,1,1] neg_hi:[0,1,0]
    v_pk_mul_f32 v[18:19], v[8:9], v[60:61] op_sel:[0,0] op_sel_hi:[1,0]
    v_pk_fma_f32 v[8:9], v[8:9], v[60:61], v[18:19] op_sel:[1,1,0] op_sel_hi:[0,1,1] neg_hi:[0,1,0]
    v_pk_mul_f32 v[18:19], v[38:39], v[62:63] op_sel:[0,0] op_sel_hi:[1,0]
    v_pk_fma_f32 v[38:39], v[38:39], v[62:63], v[18:19] op_sel:[1,1,0] op_sel_hi:[0,1,1] neg_hi:[0,1,0]
    v_pk_mul_f32 v[18:19], v[36:37], v[64:65] op_sel:[0,0] op_sel_hi:[1,0]
    v_pk_fma_f32 v[36:37], v[36:37], v[64:65], v[18:19] op_sel:[1,1,0] op_sel_hi:[0,1,1] neg_hi:[0,1,0]
    v_pk_mul_f32 v[18:19], v[14:15], v[66:67] op_sel:[0,0] op_sel_hi:[1,0]
    v_pk_fma_f32 v[14:15], v[14:15], v[66:67], v[18:19] op_sel:[1,1,0] op_sel_hi:[0,1,1] neg_hi:[0,1,0]
    v_pk_add_f32 v[18:19], v[4:5], v[8:9] neg_lo:[0,1] neg_hi:[0,1]
    v_pk_add_f32 v[4:5], v[4:5], v[8:9]
    v_pk_add_f32 v[8:9], v[6:7], v[38:39] neg_lo:[0,1] neg_hi:[0,1]
    v_pk_add_f32 v[6:7], v[6:7], v[38:39]
    v_pk_add_f32 v[38:39], v[16:17], v[36:37] neg_lo:[0,1] neg_hi:[0,1]
    v_pk_add_f32 v[16:17], v[16:17], v[36:37]
    v_pk_add_f32 v[36:37], v[10:11], v[14:15] neg_lo:[0,1] neg_hi:[0,1]
    v_pk_add_f32 v[10:11], v[10:11], v[14:15]
    v_pk_add_f32 v[14:15], v[4:5], v[16:17] neg_lo:[0,1] neg_hi:[0,1]
    v_pk_add_f32 v[4:5], v[4:5], v[16:17]
    v_pk_add_f32 v[16:17], v[6:7], v[10:11] neg_lo:[0,1] neg_hi:[0,1]
    v_pk_add_f32 v[6:7], v[6:7], v[10:11]
    v_pk_add_f32 v[10:11], v[4:5], v[6:7] neg_lo:[0,1] neg_hi:[0,1]
    v_pk_add_f32 v[4:5], v[4:5], v[6:7]
    v_pk_add_f32 v[6:7], v[14:15], v[16:17] op_sel:[0,1] op_sel_hi:[1,0] neg_hi:[0,1]
    v_pk_add_f32 v[14:15], v[14:15], v[16:17] op_sel:[0,1] op_sel_hi:[1,0] neg_lo:[0,1]
    v_pk_add_f32 v[8:9], v[8:9], v[8:9] op_sel:[0,1] op_sel_hi:[1,0] neg_lo:[0,1]
    v_pk_add_f32 v[36:37], v[36:37], v[36:37] op_sel:[0,1] op_sel_hi:[1,0] neg_hi:[0,1]
    v_pk_add_f32 v[16:17], v[18:19], v[38:39] op_sel:[0,1] op_sel_hi:[1,0] neg_hi:[0,1]
    v_pk_add_f32 v[18:19], v[18:19], v[38:39] op_sel:[0,1] op_sel_hi:[1,0] neg_lo:[0,1]
    v_pk_add_f32 v[38:39], v[8:9], v[36:37] neg_lo:[0,1] neg_hi:[0,1]
    v_pk_add_f32 v[8:9], v[8:9], v[36:37]
    v_pk_fma_f32 v[36:37], v[38:39], s[40:41], v[18:19] op_sel_hi:[1,0,1] neg_lo:[1,0,0] neg_hi:[1,0,0]
    v_pk_fma_f32 v[18:19], v[38:39], s[40:41], v[18:19] op_sel_hi:[1,0,1]
    v_pk_fma_f32 v[38:39], v[8:9], s[40:41], v[16:17] op_sel:[1,0,0] op_sel_hi:[0,0,1] neg_hi:[1,0,0]
    v_pk_fma_f32 v[16:17], v[8:9], s[40:41], v[16:17] op_sel:[1,0,0] op_sel_hi:[0,0,1] neg_lo:[1,0,0]
    ds_write_b64 v83, v[4:5] offset:18432
    ds_write_b64 v83, v[18:19] offset:18720
    ds_write_b64 v83, v[14:15] offset:19008
    ds_write_b64 v83, v[16:17] offset:19296
    ds_write_b64 v83, v[10:11] offset:19584
    ds_write_b64 v83, v[36:37] offset:19872
    ds_write_b64 v83, v[6:7] offset:20160
    ds_write_b64 v83, v[38:39] offset:20448
    s_waitcnt lgkmcnt(0)
    s_barrier
    ds_read_b64 v[4:5], v82 offset:18432
    ds_read_b64 v[18:19], v82 offset:20736
    ds_read_b64 v[14:15], v82 offset:23040
    ds_read_b64 v[16:17], v82 offset:25344
    ds_read_b64 v[10:11], v82 offset:27648
    ds_read_b64 v[36:37], v82 offset:29952
    ds_read_b64 v[6:7], v82 offset:32256
    ds_read_b64 v[38:39], v82 offset:34560
    s_waitcnt lgkmcnt(0)
    v_pk_mul_f32 v[8:9], v[18:19], v[40:41] op_sel:[0,0] op_sel_hi:[1,0]
    v_pk_fma_f32 v[18:19], v[18:19], v[40:41], v[8:9] op_sel:[1,1,0] op_sel_hi:[0,1,1] neg_hi:[0,1,0]
    v_pk_mul_f32 v[8:9], v[14:15], v[42:43] op_sel:[0,0] op_sel_hi:[1,0]
    v_pk_fma_f32 v[14:15], v[14:15], v[42:43], v[8:9] op_sel:[1,1,0] op_sel_hi:[0,1,1] neg_hi:[0,1,0]
    v_pk_mul_f32 v[8:9], v[16:17], v[44:45] op_sel:[0,0] op_sel_hi:[1,0]
    v_pk_fma_f32 v[16:17], v[16:17], v[44:45], v[8:9] op_sel:[1,1,0] op_sel_hi:[0,1,1] neg_hi:[0,1,0]
    v_pk_mul_f32 v[8:9], v[10:11], v[46:47] op_sel:[0,0] op_sel_hi:[1,0]
    v_pk_fma_f32 v[10:11], v[10:11], v[46:47], v[8:9] op_sel:[1,1,0] op_sel_hi:[0,1,1] neg_hi:[0,1,0]
    v_pk_mul_f32 v[8:9], v[36:37], v[48:49] op_sel:[0,0] op_sel_hi:[1,0]
    v_pk_fma_f32 v[36:37], v[36:37], v[48:49], v[8:9] op_sel:[1,1,0] op_sel_hi:[0,1,1] neg_hi:[0,1,0]
    v_pk_mul_f32 v[8:9], v[6:7], v[50:51] op_sel:[0,0] op_sel_hi:[1,0]
    v_pk_fma_f32 v[6:7], v[6:7], v[50:51], v[8:9] op_sel:[1,1,0] op_sel_hi:[0,1,1] neg_hi:[0,1,0]
    v_pk_mul_f32 v[8:9], v[38:39], v[52:53] op_sel:[0,0] op_sel_hi:[1,0]
    v_pk_fma_f32 v[38:39], v[38:39], v[52:53], v[8:9] op_sel:[1,1,0] op_sel_hi:[0,1,1] neg_hi:[0,1,0]
    v_pk_add_f32 v[8:9], v[4:5], v[10:11] neg_lo:[0,1] neg_hi:[0,1]
    v_pk_add_f32 v[4:5], v[4:5], v[10:11]
    v_pk_add_f32 v[10:11], v[18:19], v[36:37] neg_lo:[0,1] neg_hi:[0,1]
    v_pk_add_f32 v[18:19], v[18:19], v[36:37]
    v_pk_add_f32 v[36:37], v[14:15], v[6:7] neg_lo:[0,1] neg_hi:[0,1]
    v_pk_add_f32 v[14:15], v[14:15], v[6:7]
    v_pk_add_f32 v[6:7], v[16:17], v[38:39] neg_lo:[0,1] neg_hi:[0,1]
    v_pk_add_f32 v[16:17], v[16:17], v[38:39]
    v_pk_add_f32 v[38:39], v[4:5], v[14:15] neg_lo:[0,1] neg_hi:[0,1]
    v_pk_add_f32 v[4:5], v[4:5], v[14:15]
    v_pk_add_f32 v[14:15], v[18:19], v[16:17] neg_lo:[0,1] neg_hi:[0,1]
    v_pk_add_f32 v[18:19], v[18:19], v[16:17]
    v_pk_add_f32 v[16:17], v[4:5], v[18:19] neg_lo:[0,1] neg_hi:[0,1]
    v_pk_add_f32 v[4:5], v[4:5], v[18:19]
    v_pk_add_f32 v[18:19], v[38:39], v[14:15] op_sel:[0,1] op_sel_hi:[1,0] neg_hi:[0,1]
    v_pk_add_f32 v[38:39], v[38:39], v[14:15] op_sel:[0,1] op_sel_hi:[1,0] neg_lo:[0,1]
    v_pk_add_f32 v[10:11], v[10:11], v[10:11] op_sel:[0,1] op_sel_hi:[1,0] neg_lo:[0,1]
    v_pk_add_f32 v[6:7], v[6:7], v[6:7] op_sel:[0,1] op_sel_hi:[1,0] neg_hi:[0,1]
    v_pk_add_f32 v[14:15], v[8:9], v[36:37] op_sel:[0,1] op_sel_hi:[1,0] neg_hi:[0,1]
    v_pk_add_f32 v[8:9], v[8:9], v[36:37] op_sel:[0,1] op_sel_hi:[1,0] neg_lo:[0,1]
    v_pk_add_f32 v[36:37], v[10:11], v[6:7] neg_lo:[0,1] neg_hi:[0,1]
    v_pk_add_f32 v[10:11], v[10:11], v[6:7]
    v_pk_fma_f32 v[6:7], v[36:37], s[40:41], v[8:9] op_sel_hi:[1,0,1] neg_lo:[1,0,0] neg_hi:[1,0,0]
    v_pk_fma_f32 v[8:9], v[36:37], s[40:41], v[8:9] op_sel_hi:[1,0,1]
    v_pk_fma_f32 v[36:37], v[10:11], s[40:41], v[14:15] op_sel:[1,0,0] op_sel_hi:[0,0,1] neg_hi:[1,0,0]
    v_pk_fma_f32 v[14:15], v[10:11], s[40:41], v[14:15] op_sel:[1,0,0] op_sel_hi:[0,0,1] neg_lo:[1,0,0]
    v_lshrrev_b32 v86, 3, v0
    v_mul_u32_u24 v86, 20544, v86
    v_and_b32 v87, 7, v0
    v_lshl_add_u32 v86, v87, 3, v86
    s_lshl_b32 s12, s2, 6
    s_add_u32 s13, s12, 0
    buffer_store_dwordx2 v[4:5], v86, s[20:23], s13 offen
    s_add_u32 s13, s12, 657408
    buffer_store_dwordx2 v[8:9], v86, s[20:23], s13 offen
    s_add_u32 s13, s12, 1314816
    buffer_store_dwordx2 v[38:39], v86, s[20:23], s13 offen
    s_add_u32 s13, s12, 1972224
    buffer_store_dwordx2 v[14:15], v86, s[20:23], s13 offen
    s_add_u32 s13, s12, 2629632
    buffer_store_dwordx2 v[16:17], v86, s[20:23], s13 offen
    s_add_u32 s13, s12, 3287040
    buffer_store_dwordx2 v[6:7], v86, s[20:23], s13 offen
    s_add_u32 s13, s12, 3944448
    buffer_store_dwordx2 v[18:19], v86, s[20:23], s13 offen
    s_add_u32 s13, s12, 4601856
    buffer_store_dwordx2 v[36:37], v86, s[20:23], s13 offen
    s_endpgm
L_k2x_4:
    s_cmp_ge_u32 s2, 501
    s_cbranch_scc1 L_k2end_5
    v_and_b32 v1, 63, v0
    v_lshrrev_b32 v2, 6, v0
    s_nop 0
    v_readfirstlane_b32 s3, v2
    s_sub_u32 s14, s2, 321
    s_lshl_b32 s14, s14, 2
    s_add_u32 s14, s14, s3
    s_cmp_ge_u32 s14, 480
    s_cbranch_scc1 L_rl_wd_6
    s_load_dwordx4 s[8:11], s[0:1], 32
    s_mov_b32 s36, 0x05040100
    s_mov_b32 s37, 0x07060302
    s_mul_i32 s20, s14, 43691
    s_lshr_b32 s20, s20, 17
    s_mul_i32 s21, s20, 3
    s_sub_u32 s21, s14, s21
    s_and_b32 s15, s20, 1
    s_lshr_b32 s20, s20, 1
    s_waitcnt lgkmcnt(0)
    s_mov_b32 s28, s6
    s_and_b32 s29, s7, 0xffff
    s_mov_b32 s30, 0x10000000
    s_mov_b32 s31, 0x00020000
    s_cmp_eq_u32 s15, 1
    s_cbranch_scc1 L_rl_up_7
    s_mov_b32 s16, s8
    s_and_b32 s17, s9, 0xffff
    s_mov_b32 s18, 0x1e0000
    s_mov_b32 s19, 0x00020000
    s_branch L_rl_go_8
L_rl_up_7:
    s_mov_b32 s16, s10
    s_and_b32 s17, s11, 0xffff
    s_mov_b32 s18, 0x1e0000
    s_mov_b32 s19, 0x00020000
L_rl_go_8:
    s_lshl_b32 s22, s21, 6
    v_add_u32 v3, s22, v1
    v_lshlrev_b32 v4, 4, v3
    s_mul_i32 s22, s20, 24576
    s_add_u32 s24, s22, 0
    buffer_load_dwordx4 v[8:11], v4, s[16:19], s24 offen
    s_add_u32 s24, s22, 3072
    buffer_load_dwordx4 v[12:15], v4, s[16:19], s24 offen
    s_add_u32 s24, s22, 6144
    buffer_load_dwordx4 v[16:19], v4, s[16:19], s24 offen
    s_add_u32 s24, s22, 9216
    buffer_load_dwordx4 v[20:23], v4, s[16:19], s24 offen
    s_add_u32 s24, s22, 12288
    buffer_load_dwordx4 v[24:27], v4, s[16:19], s24 offen
    s_add_u32 s24, s22, 15360
    buffer_load_dwordx4 v[28:31], v4, s[16:19], s24 offen
    s_add_u32 s24, s22, 18432
    buffer_load_dwordx4 v[32:35], v4, s[16:19], s24 offen
    s_add_u32 s24, s22, 21504
    buffer_load_dwordx4 v[36:39], v4, s[16:19], s24 offen
    v_lshrrev_b32 v5, 1, v3
    v_mul_u32_u24 v5, 40960, v5
    v_and_b32 v6, 1, v3
    v_lshl_add_u32 v5, v6, 7, v5
    s_lshr_b32 s22, s20, 1
    s_lshl_b32 s22, s22, 10
    s_and_b32 s23, s20, 1
    s_lshl_b32 s23, s23, 9
    s_add_u32 s22, s22, s23
    s_lshl_b32 s23, s15, 8
    s_add_u32 s22, s22, s23
    s_add_u32 s22, s22, 0x1800000
    s_waitcnt vmcnt(0)
    v_perm_b32 v40, v12, v8, s36
    v_perm_b32 v41, v20, v16, s36
    v_perm_b32 v42, v28, v24, s36
    v_perm_b32 v43, v36, v32, s36
    v_perm_b32 v44, v12, v8, s37
    v_perm_b32 v45, v20, v16, s37
    v_perm_b32 v46, v28, v24, s37
    v_perm_b32 v47, v36, v32, s37
    v_perm_b32 v48, v13, v9, s36
    v_perm_b32 v49, v21, v17, s36
    v_perm_b32 v50, v29, v25, s36
    v_perm_b32 v51, v37, v33, s36
    v_perm_b32 v52, v13, v9, s37
    v_perm_b32 v53, v21, v17, s37
    v_perm_b32 v54, v29, v25, s37
    v_perm_b32 v55, v37, v33, s37
    v_perm_b32 v56, v14, v10, s36
    v_perm_b32 v57, v22, v18, s36
    v_perm_b32 v58, v30, v26, s36
    v_perm_b32 v59, v38, v34, s36
    v_perm_b32 v60, v14, v10, s37
    v_perm_b32 v61, v22, v18, s37
    v_perm_b32 v62, v30, v26, s37
    v_perm_b32 v63, v38, v34, s37
    v_perm_b32 v64, v15, v11, s36
    v_perm_b32 v65, v23, v19, s36
    v_perm_b32 v66, v31, v27, s36
    v_perm_b32 v67, v39, v35, s36
    v_perm_b32 v68, v15, v11, s37
    v_perm_b32 v69, v23, v19, s37
    v_perm_b32 v70, v31, v27, s37
    v_perm_b32 v71, v39, v35, s37
    s_mul_i32 s26, s3, 9216
    v_mul_u32_u24 v72, 144, v1
    v_add_u32 v72, s26, v72
    ds_write_b128 v72, v[40:43] offset:0
    ds_write_b128 v72, v[44:47] offset:16
    ds_write_b128 v72, v[48:51] offset:32
    ds_write_b128 v72, v[52:55] offset:48
    ds_write_b128 v72, v[56:59] offset:64
    ds_write_b128 v72, v[60:63] offset:80
    ds_write_b128 v72, v[64:67] offset:96
    ds_write_b128 v72, v[68:71] offset:112
    v_lshrrev_b32 v73, 3, v1
    v_mul_u32_u24 v74, 144, v73
    v_and_b32 v75, 7, v1
    v_lshl_add_u32 v74, v75, 4, v74
    v_add_u32 v74, s26, v74
    v_lshlrev_b32 v73, 2, v73
    v_lshlrev_b32 v75, 4, v75
    s_waitcnt lgkmcnt(0)
    ds_read_b128 v[40:43], v74 offset:0
    ds_bpermute_b32 v8, v73, v5 offset:0
    ds_read_b128 v[44:47], v74 offset:1152
    ds_bpermute_b32 v9, v73, v5 offset:32
    ds_read_b128 v[48:51], v74 offset:2304
    ds_bpermute_b32 v10, v73, v5 offset:64
    ds_read_b128 v[52:55], v74 offset:3456
    ds_bpermute_b32 v11, v73, v5 offset:96
    ds_read_b128 v[56:59], v74 offset:4608
    ds_bpermute_b32 v12, v73, v5 offset:128
    ds_read_b128 v[60:63], v74 offset:5760
    ds_bpermute_b32 v13, v73, v5 offset:160
    ds_read_b128 v[64:67], v74 offset:6912
    ds_bpermute_b32 v14, v73, v5 offset:192
    ds_read_b128 v[68:71], v74 offset:8064
    ds_bpermute_b32 v15, v73, v5 offset:224
    s_waitcnt lgkmcnt(0)
    v_add_u32 v8, v8, v75
    v_add_u32 v9, v9, v75
    v_add_u32 v10, v10, v75
    v_add_u32 v11, v11, v75
    v_add_u32 v12, v12, v75
    v_add_u32 v13, v13, v75
    v_add_u32 v14, v14, v75
    v_add_u32 v15, v15, v75
    buffer_store_dwordx4 v[40:43], v8, s[28:31], s22 offen
    buffer_store_dwordx4 v[44:47], v9, s[28:31], s22 offen
    buffer_store_dwordx4 v[48:51], v10, s[28:31], s22 offen
    buffer_store_dwordx4 v[52:55], v11, s[28:31], s22 offen
    buffer_store_dwordx4 v[56:59], v12, s[28:31], s22 offen
    buffer_store_dwordx4 v[60:63], v13, s[28:31], s22 offen
    buffer_store_dwordx4 v[64:67], v14, s[28:31], s22 offen
    buffer_store_dwordx4 v[68:71], v15, s[28:31], s22 offen
    s_endpgm
L_rl_wd_6:
    s_sub_u32 s14, s14, 480
    s_load_dwordx2 s[12:13], s[0:1], 48
    s_mov_b32 s36, 0x05040100
    s_mov_b32 s37, 0x07060302
    s_lshl_b32 s14, s14, 6
    v_add_u32 v3, s14, v1
    s_mov_b32 s20, 52429
    v_mul_lo_u32 v4, v3, s20
    v_lshrrev_b32 v4, 22, v4
    v_mul_u32_u24 v5, 80, v4
    v_sub_u32 v5, v3, v5
    v_mul_u32_u24 v6, 10240, v4
    v_lshl_add_u32 v6, v5, 4, v6
    s_waitcnt lgkmcnt(0)
    s_mov_b32 s28, s6
    s_and_b32 s29, s7, 0xffff
    s_mov_b32 s30, 0x10000000
    s_mov_b32 s31, 0x00020000
    s_mov_b32 s16, s12
    s_and_b32 s17, s13, 0xffff
    s_mov_b32 s18, 0x1e0000
    s_mov_b32 s19, 0x00020000
    buffer_load_dwordx4 v[8:11], v6, s[16:19], 0 offen offset:0
    buffer_load_dwordx4 v[12:15], v6, s[16:19], 0 offen offset:1280
    buffer_load_dwordx4 v[16:19], v6, s[16:19], 0 offen offset:2560
    buffer_load_dwordx4 v[20:23], v6, s[16:19], 0 offen offset:3840
    s_movk_i32 s24, 5120
    buffer_load_dwordx4 v[24:27], v6, s[16:19], s24 offen offset:0
    buffer_load_dwordx4 v[28:31], v6, s[16:19], s24 offen offset:1280
    buffer_load_dwordx4 v[32:35], v6, s[16:19], s24 offen offset:2560
    buffer_load_dwordx4 v[36:39], v6, s[16:19], s24 offen offset:3840
    v_lshrrev_b32 v7, 1, v5
    v_mul_u32_u24 v7, 49152, v7
    v_lshrrev_b32 v3, 2, v4
    v_lshl_add_u32 v7, v3, 10, v7
    v_and_b32 v3, 3, v4
    v_lshl_add_u32 v7, v3, 8, v7
    v_and_b32 v3, 1, v5
    v_lshl_add_u32 v7, v3, 7, v7
    s_mov_b32 s22, 0x1c00000
    s_waitcnt vmcnt(0)
    v_perm_b32 v40, v12, v8, s36
    v_perm_b32 v41, v20, v16, s36
    v_perm_b32 v42, v28, v24, s36
    v_perm_b32 v43, v36, v32, s36
    v_perm_b32 v44, v12, v8, s37
    v_perm_b32 v45, v20, v16, s37
    v_perm_b32 v46, v28, v24, s37
    v_perm_b32 v47, v36, v32, s37
    v_perm_b32 v48, v13, v9, s36
    v_perm_b32 v49, v21, v17, s36
    v_perm_b32 v50, v29, v25, s36
    v_perm_b32 v51, v37, v33, s36
    v_perm_b32 v52, v13, v9, s37
    v_perm_b32 v53, v21, v17, s37
    v_perm_b32 v54, v29, v25, s37
    v_perm_b32 v55, v37, v33, s37
    v_perm_b32 v56, v14, v10, s36
    v_perm_b32 v57, v22, v18, s36
    v_perm_b32 v58, v30, v26, s36
    v_perm_b32 v59, v38, v34, s36
    v_perm_b32 v60, v14, v10, s37
    v_perm_b32 v61, v22, v18, s37
    v_perm_b32 v62, v30, v26, s37
    v_perm_b32 v63, v38, v34, s37
    v_perm_b32 v64, v15, v11, s36
    v_perm_b32 v65, v23, v19, s36
    v_perm_b32 v66, v31, v27, s36
    v_perm_b32 v67, v39, v35, s36
    v_perm_b32 v68, v15, v11, s37
    v_perm_b32 v69, v23, v19, s37
    v_perm_b32 v70, v31, v27, s37
    v_perm_b32 v71, v39, v35, s37
    s_mul_i32 s26, s3, 9216
    v_mul_u32_u24 v72, 144, v1
    v_add_u32 v72, s26, v72
    ds_write_b128 v72, v[40:43] offset:0
    ds_write_b128 v72, v[44:47] offset:16
    ds_write_b128 v72, v[48:51] offset:32
    ds_write_b128 v72, v[52:55] offset:48
    ds_write_b128 v72, v[56:59] offset:64
    ds_write_b128 v72, v[60:63] offset:80
    ds_write_b128 v72, v[64:67] offset:96
    ds_write_b128 v72, v[68:71] offset:112
    v_lshrrev_b32 v73, 3, v1
    v_mul_u32_u24 v74, 144, v73
    v_and_b32 v75, 7, v1
    v_lshl_add_u32 v74, v75, 4, v74
    v_add_u32 v74, s26, v74
    v_lshlrev_b32 v73, 2, v73
    v_lshlrev_b32 v75, 4, v75
    s_waitcnt lgkmcnt(0)
    ds_read_b128 v[40:43], v74 offset:0
    ds_bpermute_b32 v8, v73, v7 offset:0
    ds_read_b128 v[44:47], v74 offset:1152
    ds_bpermute_b32 v9, v73, v7 offset:32
    ds_read_b128 v[48:51], v74 offset:2304
    ds_bpermute_b32 v10, v73, v7 offset:64
    ds_read_b128 v[52:55], v74 offset:3456
    ds_bpermute_b32 v11, v73, v7 offset:96
    ds_read_b128 v[56:59], v74 offset:4608
    ds_bpermute_b32 v12, v73, v7 offset:128
    ds_read_b128 v[60:63], v74 offset:5760
    ds_bpermute_b32 v13, v73, v7 offset:160
    ds_read_b128 v[64:67], v74 offset:6912
    ds_bpermute_b32 v14, v73, v7 offset:192
    ds_read_b128 v[68:71], v74 offset:8064
    ds_bpermute_b32 v15, v73, v7 offset:224
    s_waitcnt lgkmcnt(0)
    v_add_u32 v8, v8, v75
    v_add_u32 v9, v9, v75
    v_add_u32 v10, v10, v75
    v_add_u32 v11, v11, v75
    v_add_u32 v12, v12, v75
    v_add_u32 v13, v13, v75
    v_add_u32 v14, v14, v75
    v_add_u32 v15, v15, v75
    buffer_store_dwordx4 v[40:43], v8, s[28:31], s22 offen
    buffer_store_dwordx4 v[44:47], v9, s[28:31], s22 offen
    buffer_store_dwordx4 v[48:51], v10, s[28:31], s22 offen
    buffer_store_dwordx4 v[52:55], v11, s[28:31], s22 offen
    buffer_store_dwordx4 v[56:59], v12, s[28:31], s22 offen
    buffer_store_dwordx4 v[60:63], v13, s[28:31], s22 offen
    buffer_store_dwordx4 v[64:67], v14, s[28:31], s22 offen
    buffer_store_dwordx4 v[68:71], v15, s[28:31], s22 offen
    s_endpgm
L_k2end_5:
    s_endpgm
.globl k3_kernel
.p2align 8
.type k3_kernel,@function
k3_kernel:
    s_cmp_ge_u32 s2, 256
    s_cbranch_scc1 L_k3pf_10
    s_load_dwordx2 s[4:5], s[0:1], 0
    s_load_dwordx2 s[6:7], s[0:1], 72
    v_and_b32 v1, 63, v0
    v_lshrrev_b32 v2, 6, v0
    s_nop 0
    v_readfirstlane_b32 s3, v2
    s_mov_b32 s40, 0x3f3504f3
    s_mov_b32 s41, 0x3f3504f3
    s_mov_b32 s42, 0x3e9e377a
    s_mov_b32 s43, 0x3e9e377a
    s_mov_b32 s44, 0xbf4f1bbd
    s_mov_b32 s45, 0xbf4f1bbd
    s_mov_b32 s46, 0x3f737871
    s_mov_b32 s47, 0x3f737871
    s_mov_b32 s48, 0x3f167918
    s_mov_b32 s49, 0x3f167918
    s_mov_b32 s50, 0x3acccccd
    s_mov_b32 s52, 0x34cccccd
    s_mov_b32 s53, 0x34cccccd
    s_and_b32 s12, s2, 7
    s_lshl_b32 s12, s12, 5
    s_lshr_b32 s13, s2, 3
    s_add_u32 s51, s12, s13
    s_lshl_b32 s12, s51, 3
    s_add_u32 s12, s12, s3
    s_mul_i32 s13, s12, 1280
    v_lshlrev_b32 v3, 2, v1
    v_lshrrev_b32 v4, 2, v0
    v_and_b32 v5, 3, v0
    v_mul_u32_u24 v6, 80, v4
    v_lshlrev_b32 v5, 4, v5
    v_add_u32 v6, v6, v5
    v_add_u32 v6, 23040, v6
    v_lshlrev_b32 v7, 4, v0
    s_mul_i32 s34, s51, 20544
    s_add_u32 s35, s34, 8192
    s_add_u32 s36, s34, 16384
    s_waitcnt lgkmcnt(0)
    s_mov_b32 s16, s4
    s_and_b32 s17, s5, 0xffff
    s_mov_b32 s18, 0x280000
    s_mov_b32 s19, 0x00020000
    s_add_u32 s20, s6, 0x600000
    s_addc_u32 s21, s7, 0
    s_and_b32 s21, s21, 0xffff
    s_mov_b32 s22, 0x504000
    s_mov_b32 s23, 0x00020000
    s_add_u32 s24, s6, 0x1000000
    s_addc_u32 s25, s7, 0
    s_and_b32 s25, s25, 0xffff
    s_mov_b32 s26, 0x280000
    s_mov_b32 s27, 0x00020000
    s_add_u32 s28, s6, 0x1400000
    s_addc_u32 s29, s7, 0
    s_and_b32 s29, s29, 0xffff
    s_mov_b32 s30, 0x280000
    s_mov_b32 s31, 0x00020000
    buffer_load_dwordx4 v[8:11], v7, s[20:23], s34 offen
    buffer_load_dwordx4 v[12:15], v7, s[20:23], s35 offen
    buffer_load_dwordx4 v[16:19], v7, s[20:23], s36 offen
    buffer_load_dword v84, v3, s[16:19], s13 offen offset:0
    buffer_load_dword v85, v3, s[16:19], s13 offen offset:256
    buffer_load_dword v86, v3, s[16:19], s13 offen offset:512
    buffer_load_dword v87, v3, s[16:19], s13 offen offset:768
    buffer_load_dword v88, v3, s[16:19], s13 offen offset:1024
    v_cvt_f32_u32 v20, v1
    v_mul_f32 v21, 0xbb4ccccd, v20
    v_cos_f32 v40, v21
    v_sin_f32 v41, v21
    s_nop 0
    v_pk_mul_f32 v[22:23], v[40:41], v[40:41] op_sel:[0,0] op_sel_hi:[1,0]
    v_pk_fma_f32 v[42:43], v[40:41], v[40:41], v[22:23] op_sel:[1,1,0] op_sel_hi:[0,1,1] neg_lo:[0,1,0]
    v_pk_mul_f32 v[22:23], v[40:41], v[42:43] op_sel:[0,0] op_sel_hi:[1,0]
    v_pk_fma_f32 v[44:45], v[40:41], v[42:43], v[22:23] op_sel:[1,1,0] op_sel_hi:[0,1,1] neg_lo:[0,1,0]
    v_pk_mul_f32 v[22:23], v[42:43], v[42:43] op_sel:[0,0] op_sel_hi:[1,0]
    v_pk_fma_f32 v[46:47], v[42:43], v[42:43], v[22:23] op_sel:[1,1,0] op_sel_hi:[0,1,1] neg_lo:[0,1,0]
    v_and_b32 v21, 7, v1
    v_cvt_f32_u32 v21, v21
    v_mul_f32 v21, 0xbc800000, v21
    v_cos_f32 v48, v21
    v_sin_f32 v49, v21
    s_nop 0
    v_pk_mul_f32 v[22:23], v[48:49], v[48:49] op_sel:[0,0] op_sel_hi:[1,0]
    v_pk_fma_f32 v[50:51], v[48:49], v[48:49], v[22:23] op_sel:[1,1,0] op_sel_hi:[0,1,1] neg_lo:[0,1,0]
    v_pk_mul_f32 v[22:23], v[48:49], v[50:51] op_sel:[0,0] op_sel_hi:[1,0]
    v_pk_fma_f32 v[52:53], v[48:49], v[50:51], v[22:23] op_sel:[1,1,0] op_sel_hi:[0,1,1] neg_lo:[0,1,0]
    v_pk_mul_f32 v[22:23], v[50:51], v[50:51] op_sel:[0,0] op_sel_hi:[1,0]
    v_pk_fma_f32 v[54:55], v[50:51], v[50:51], v[22:23] op_sel:[1,1,0] op_sel_hi:[0,1,1] neg_lo:[0,1,0]
    v_pk_mul_f32 v[22:23], v[50:51], v[52:53] op_sel:[0,0] op_sel_hi:[1,0]
    v_pk_fma_f32 v[56:57], v[50:51], v[52:53], v[22:23] op_sel:[1,1,0] op_sel_hi:[0,1,1] neg_lo:[0,1,0]
    v_pk_mul_f32 v[22:23], v[52:53], v[52:53] op_sel:[0,0] op_sel_hi:[1,0]
    v_pk_fma_f32 v[58:59], v[52:53], v[52:53], v[22:23] op_sel:[1,1,0] op_sel_hi:[0,1,1] neg_lo:[0,1,0]
    v_pk_mul_f32 v[22:23], v[52:53], v[54:55] op_sel:[0,0] op_sel_hi:[1,0]
    v_pk_fma_f32 v[60:61], v[52:53], v[54:55], v[22:23] op_sel:[1,1,0] op_sel_hi:[0,1,1] neg_lo:[0,1,0]
    v_mov_b32 v21, 0x80000000
    v_fmac_f32 v21, 0xbacccccd, v20
    v_sin_f32 v62, v21
    v_cos_f32 v63, v21
    v_mov_b32 v21, 0xbdcccccd
    v_fmac_f32 v21, 0xbacccccd, v20
    v_sin_f32 v64, v21
    v_cos_f32 v65, v21
    v_mov_b32 v21, 0xbe4ccccd
    v_fmac_f32 v21, 0xbacccccd, v20
    v_sin_f32 v66, v21
    v_cos_f32 v67, v21
    v_mov_b32 v21, 0xbe99999a
    v_fmac_f32 v21, 0xbacccccd, v20
    v_sin_f32 v68, v21
    v_cos_f32 v69, v21
    v_mov_b32 v21, 0xbecccccd
    v_fmac_f32 v21, 0xbacccccd, v20
    v_sin_f32 v70, v21
    v_cos_f32 v71, v21
    s_mul_i32 s14, s3, 2880
    v_lshlrev_b32 v72, 3, v1
    v_add_u32 v72, s14, v72
    v_lshrrev_b32 v73, 3, v1
    v_mul_u32_u24 v74, 576, v73
    v_and_b32 v75, 7, v1
    v_lshlrev_b32 v76, 3, v75
    v_add3_u32 v76, v74, v76, s14
    v_mul_u32_u24 v77, 72, v75
    v_add3_u32 v77, v74, v77, s14
    v_mul_u32_u24 v78, 5, v75
    v_add_u32 v78, v78, v73
    v_lshlrev_b32 v78, 3, v78
    v_add_u32 v78, s14, v78
    s_lshl_b32 s15, s3, 3
    s_add_u32 s15, s15, 23040
    v_mul_u32_u24 v80, 80, v1
    v_add_u32 v80, s15, v80
    v_sub_u32 v81, 64, v1
    v_mul_u32_u24 v81, 80, v81
    v_add_u32 v81, s15, v81
    v_cmp_gt_u32 vcc, 260, v0
    s_and_saveexec_b64 s[32:33], vcc
    s_waitcnt vmcnt(5)
    ds_write_b128 v6, v[16:19] offset:20480
    s_mov_b64 exec, s[32:33]
    ds_write_b128 v6, v[8:11]
    ds_write_b128 v6, v[12:15] offset:10240
    s_waitcnt lgkmcnt(0)
    s_barrier
    ds_read_b64 v[38:39], v80 offset:0
    ds_read_b64 v[28:29], v81 offset:20480
    ds_read_b64 v[36:37], v80 offset:5120
    ds_read_b64 v[26:27], v81 offset:15360
    ds_read_b64 v[34:35], v80 offset:10240
    ds_read_b64 v[24:25], v81 offset:10240
    ds_read_b64 v[32:33], v80 offset:15360
    ds_read_b64 v[22:23], v81 offset:5120
    ds_read_b64 v[30:31], v80 offset:20480
    ds_read_b64 v[20:21], v81 offset:0
    s_waitcnt lgkmcnt(0)
    s_mov_b64 exec, 1
    v_mov_b32 v39, 0
    v_mov_b32 v29, 0
    s_mov_b64 exec, s[32:33]
    v_pk_add_f32 v[18:19], v[38:39], v[28:29] neg_hi:[0,1]
    v_pk_add_f32 v[38:39], v[38:39], v[28:29] neg_lo:[0,1]
    v_pk_fma_f32 v[16:17], v[38:39], v[62:63], v[18:19] op_sel:[0,0,0] op_sel_hi:[1,0,1]
    v_pk_fma_f32 v[38:39], v[38:39], v[62:63], v[16:17] op_sel:[1,1,0] op_sel_hi:[0,1,1] neg_lo:[0,1,0]
    ds_write_b64 v72, v[38:39] offset:0
    v_pk_add_f32 v[18:19], v[36:37], v[26:27] neg_hi:[0,1]
    v_pk_add_f32 v[36:37], v[36:37], v[26:27] neg_lo:[0,1]
    v_pk_fma_f32 v[16:17], v[36:37], v[64:65], v[18:19] op_sel:[0,0,0] op_sel_hi:[1,0,1]
    v_pk_fma_f32 v[36:37], v[36:37], v[64:65], v[16:17] op_sel:[1,1,0] op_sel_hi:[0,1,1] neg_lo:[0,1,0]
    ds_write_b64 v72, v[36:37] offset:512
    v_pk_add_f32 v[18:19], v[34:35], v[24:25] neg_hi:[0,1]
    v_pk_add_f32 v[34:35], v[34:35], v[24:25] neg_lo:[0,1]
    v_pk_fma_f32 v[16:17], v[34:35], v[66:67], v[18:19] op_sel:[0,0,0] op_sel_hi:[1,0,1]
    v_pk_fma_f32 v[34:35], v[34:35], v[66:67], v[16:17] op_sel:[1,1,0] op_sel_hi:[0,1,1] neg_lo:[0,1,0]
    ds_write_b64 v72, v[34:35] offset:1024
    v_pk_add_f32 v[18:19], v[32:33], v[22:23] neg_hi:[0,1]
    v_pk_add_f32 v[32:33], v[32:33], v[22:23] neg_lo:[0,1]
    v_pk_fma_f32 v[16:17], v[32:33], v[68:69], v[18:19] op_sel:[0,0,0] op_sel_hi:[1,0,1]
    v_pk_fma_f32 v[32:33], v[32:33], v[68:69], v[16:17] op_sel:[1,1,0] op_sel_hi:[0,1,1] neg_lo:[0,1,0]
    ds_write_b64 v72, v[32:33] offset:1536
    v_pk_add_f32 v[18:19], v[30:31], v[20:21] neg_hi:[0,1]
    v_pk_add_f32 v[30:31], v[30:31], v[20:21] neg_lo:[0,1]
    v_pk_fma_f32 v[16:17], v[30:31], v[70:71], v[18:19] op_sel:[0,0,0] op_sel_hi:[1,0,1]
    v_pk_fma_f32 v[30:31], v[30:31], v[70:71], v[16:17] op_sel:[1,1,0] op_sel_hi:[0,1,1] neg_lo:[0,1,0]
    ds_write_b64 v72, v[30:31] offset:2048
    s_waitcnt lgkmcnt(0)
    ds_read_b64 v[20:21], v78 offset:0
    ds_read_b64 v[22:23], v78 offset:320
    ds_read_b64 v[24:25], v78 offset:640
    ds_read_b64 v[26:27], v78 offset:960
    ds_read_b64 v[28:29], v78 offset:1280
    ds_read_b64 v[30:31], v78 offset:1600
    ds_read_b64 v[32:33], v78 offset:1920
    ds_read_b64 v[34:35], v78 offset:2240
    s_waitcnt lgkmcnt(0)
    v_pk_add_f32 v[36:37], v[20:21], v[28:29] neg_lo:[0,1] neg_hi:[0,1]
    v_pk_add_f32 v[20:21], v[20:21], v[28:29]
    v_pk_add_f32 v[28:29], v[22:23], v[30:31] neg_lo:[0,1] neg_hi:[0,1]
    v_pk_add_f32 v[22:23], v[22:23], v[30:31]
    v_pk_add_f32 v[30:31], v[24:25], v[32:33] neg_lo:[0,1] neg_hi:[0,1]
    v_pk_add_f32 v[24:25], v[24:25], v[32:33]
    v_pk_add_f32 v[32:33], v[26:27], v[34:35] neg_lo:[0,1] neg_hi:[0,1]
    v_pk_add_f32 v[26:27], v[26:27], v[34:35]
    v_pk_add_f32 v[34:35], v[20:21], v[24:25] neg_lo:[0,1] neg_hi:[0,1]
    v_pk_add_f32 v[20:21], v[20:21], v[24:25]
    v_pk_add_f32 v[24:25], v[22:23], v[26:27] neg_lo:[0,1] neg_hi:[0,1]
    v_pk_add_f32 v[22:23], v[22:23], v[26:27]
    v_pk_add_f32 v[26:27], v[20:21], v[22:23] neg_lo:[0,1] neg_hi:[0,1]
    v_pk_add_f32 v[20:21], v[20:21], v[22:23]
    v_pk_add_f32 v[22:23], v[34:35], v[24:25] op_sel:[0,1] op_sel_hi:[1,0] neg_hi:[0,1]
    v_pk_add_f32 v[34:35], v[34:35], v[24:25] op_sel:[0,1] op_sel_hi:[1,0] neg_lo:[0,1]
    v_pk_add_f32 v[28:29], v[28:29], v[28:29] op_sel:[0,1] op_sel_hi:[1,0] neg_lo:[0,1]
    v_pk_add_f32 v[32:33], v[32:33], v[32:33] op_sel:[0,1] op_sel_hi:[1,0] neg_hi:[0,1]
    v_pk_add_f32 v[24:25], v[36:37], v[30:31] op_sel:[0,1] op_sel_hi:[1,0] neg_hi:[0,1]
    v_pk_add_f32 v[36:37], v[36:37], v[30:31] op_sel:[0,1] op_sel_hi:[1,0] neg_lo:[0,1]
    v_pk_add_f32 v[30:31], v[28:29], v[32:33] neg_lo:[0,1] neg_hi:[0,1]
    v_pk_add_f32 v[28:29], v[28:29], v[32:33]
    v_pk_fma_f32 v[32:33], v[30:31], s[40:41], v[36:37] op_sel_hi:[1,0,1] neg_lo:[1,0,0] neg_hi:[1,0,0]
    v_pk_fma_f32 v[36:37], v[30:31], s[40:41], v[36:37] op_sel_hi:[1,0,1]
    v_pk_fma_f32 v[30:31], v[28:29], s[40:41], v[24:25] op_sel:[1,0,0] op_sel_hi:[0,0,1] neg_hi:[1,0,0]
    v_pk_fma_f32 v[24:25], v[28:29], s[40:41], v[24:25] op_sel:[1,0,0] op_sel_hi:[0,0,1] neg_lo:[1,0,0]
    v_pk_mul_f32 v[28:29], v[36:37], v[48:49] op_sel:[0,0] op_sel_hi:[1,0]
    v_pk_fma_f32 v[36:37], v[36:37], v[48:49], v[28:29] op_sel:[1,1,0] op_sel_hi:[0,1,1] neg_hi:[0,1,0]
    v_pk_mul_f32 v[28:29], v[34:35], v[50:51] op_sel:[0,0] op_sel_hi:[1,0]
    v_pk_fma_f32 v[34:35], v[34:35], v[50:51], v[28:29] op_sel:[1,1,0] op_sel_hi:[0,1,1] neg_hi:[0,1,0]
    v_pk_mul_f32 v[28:29], v[24:25], v[52:53] op_sel:[0,0] op_sel_hi:[1,0]
    v_pk_fma_f32 v[24:25], v[24:25], v[52:53], v[28:29] op_sel:[1,1,0] op_sel_hi:[0,1,1] neg_hi:[0,1,0]
    v_pk_mul_f32 v[28:29], v[26:27], v[54:55] op_sel:[0,0] op_sel_hi:[1,0]
    v_pk_fma_f32 v[26:27], v[26:27], v[54:55], v[28:29] op_sel:[1,1,0] op_sel_hi:[0,1,1] neg_hi:[0,1,0]
    v_pk_mul_f32 v[28:29], v[32:33], v[56:57] op_sel:[0,0] op_sel_hi:[1,0]
    v_pk_fma_f32 v[32:33], v[32:33], v[56:57], v[28:29] op_sel:[1,1,0] op_sel_hi:[0,1,1] neg_hi:[0,1,0]
    v_pk_mul_f32 v[28:29], v[22:23], v[58:59] op_sel:[0,0] op_sel_hi:[1,0]
    v_pk_fma_f32 v[22:23], v[22:23], v[58:59], v[28:29] op_sel:[1,1,0] op_sel_hi:[0,1,1] neg_hi:[0,1,0]
    v_pk_mul_f32 v[28:29], v[30:31], v[60:61] op_sel:[0,0] op_sel_hi:[1,0]
    v_pk_fma_f32 v[30:31], v[30:31], v[60:61], v[28:29] op_sel:[1,1,0] op_sel_hi:[0,1,1] neg_hi:[0,1,0]
    v_cmp_gt_u32 vcc, 40, v1
    s_and_saveexec_b64 s[32:33], vcc
    ds_write_b64 v77, v[20:21] offset:0
    ds_write_b64 v77, v[36:37] offset:8
    ds_write_b64 v77, v[34:35] offset:16
    ds_write_b64 v77, v[24:25] offset:24
    ds_write_b64 v77, v[26:27] offset:32
    ds_write_b64 v77, v[32:33] offset:40
    ds_write_b64 v77, v[22:23] offset:48
    ds_write_b64 v77, v[30:31] offset:56
    s_mov_b64 exec, s[32:33]
    s_waitcnt lgkmcnt(0)
    ds_read_b64 v[30:31], v76 offset:0
    ds_read_b64 v[22:23], v76 offset:72
    ds_read_b64 v[32:33], v76 offset:144
    ds_read_b64 v[26:27], v76 offset:216
    ds_read_b64 v[24:25], v76 offset:288
    ds_read_b64 v[34:35], v76 offset:360
    ds_read_b64 v[36:37], v76 offset:432
    ds_read_b64 v[20:21], v76 offset:504
    s_waitcnt lgkmcnt(0)
    v_pk_add_f32 v[28:29], v[30:31], v[24:25] neg_lo:[0,1] neg_hi:[0,1]
    v_pk_add_f32 v[30:31], v[30:31], v[24:25]
    v_pk_add_f32 v[24:25], v[22:23], v[34:35] neg_lo:[0,1] neg_hi:[0,1]
    v_pk_add_f32 v[22:23], v[22:23], v[34:35]
    v_pk_add_f32 v[34:35], v[32:33], v[36:37] neg_lo:[0,1] neg_hi:[0,1]
    v_pk_add_f32 v[32:33], v[32:33], v[36:37]
    v_pk_add_f32 v[36:37], v[26:27], v[20:21] neg_lo:[0,1] neg_hi:[0,1]
    v_pk_add_f32 v[26:27], v[26:27], v[20:21]
    v_pk_add_f32 v[20:21], v[30:31], v[32:33] neg_lo:[0,1] neg_hi:[0,1]
    v_pk_add_f32 v[30:31], v[30:31], v[32:33]
    v_pk_add_f32 v[32:33], v[22:23], v[26:27] neg_lo:[0,1] neg_hi:[0,1]
    v_pk_add_f32 v[22:23], v[22:23], v[26:27]
    v_pk_add_f32 v[26:27], v[30:31], v[22:23] neg_lo:[0,1] neg_hi:[0,1]
    v_pk_add_f32 v[30:31], v[30:31], v[22:23]
    v_pk_add_f32 v[22:23], v[20:21], v[32:33] op_sel:[0,1] op_sel_hi:[1,0] neg_hi:[0,1]
    v_pk_add_f32 v[20:21], v[20:21], v[32:33] op_sel:[0,1] op_sel_hi:[1,0] neg_lo:[0,1]
    v_pk_add_f32 v[24:25], v[24:25], v[24:25] op_sel:[0,1] op_sel_hi:[1,0] neg_lo:[0,1]
    v_pk_add_f32 v[36:37], v[36:37], v[36:37] op_sel:[0,1] op_sel_hi:[1,0] neg_hi:[0,1]
    v_pk_add_f32 v[32:33], v[28:29], v[34:35] op_sel:[0,1] op_sel_hi:[1,0] neg_hi:[0,1]
    v_pk_add_f32 v[28:29], v[28:29], v[34:35] op_sel:[0,1] op_sel_hi:[1,0] neg_lo:[0,1]
    v_pk_add_f32 v[34:35], v[24:25], v[36:37] neg_lo:[0,1] neg_hi:[0,1]
    v_pk_add_f32 v[24:25], v[24:25], v[36:37]
    v_pk_fma_f32 v[36:37], v[34:35], s[40:41], v[28:29] op_sel_hi:[1,0,1] neg_lo:[1,0,0] neg_hi:[1,0,0]
    v_pk_fma_f32 v[28:29], v[34:35], s[40:41], v[28:29] op_sel_hi:[1,0,1]
    v_pk_fma_f32 v[34:35], v[24:25], s[40:41], v[32:33] op_sel:[1,0,0] op_sel_hi:[0,0,1] neg_hi:[1,0,0]
    v_pk_fma_f32 v[32:33], v[24:25], s[40:41], v[32:33] op_sel:[1,0,0] op_sel_hi:[0,0,1] neg_lo:[1,0,0]
    s_mov_b64 exec, vcc
    ds_write_b64 v76, v[30:31] offset:0
    ds_write_b64 v76, v[28:29] offset:64
    ds_write_b64 v76, v[20:21] offset:128
    ds_write_b64 v76, v[32:33] offset:192
    ds_write_b64 v76, v[26:27] offset:256
    ds_write_b64 v76, v[36:37] offset:320
    ds_write_b64 v76, v[22:23] offset:384
    ds_write_b64 v76, v[34:35] offset:448
    s_mov_b64 exec, s[32:33]
    s_waitcnt lgkmcnt(0)
    ds_read_b64 v[34:35], v72 offset:0
    ds_read_b64 v[22:23], v72 offset:576
    ds_read_b64 v[36:37], v72 offset:1152
    ds_read_b64 v[26:27], v72 offset:1728
    ds_read_b64 v[32:33], v72 offset:2304
    s_waitcnt lgkmcnt(0)
    v_pk_mul_f32 v[20:21], v[22:23], v[40:41] op_sel:[0,0] op_sel_hi:[1,0]
    v_pk_fma_f32 v[22:23], v[22:23], v[40:41], v[20:21] op_sel:[1,1,0] op_sel_hi:[0,1,1] neg_hi:[0,1,0]
    v_pk_mul_f32 v[20:21], v[36:37], v[42:43] op_sel:[0,0] op_sel_hi:[1,0]
    v_pk_fma_f32 v[36:37], v[36:37], v[42:43], v[20:21] op_sel:[1,1,0] op_sel_hi:[0,1,1] neg_hi:[0,1,0]
    v_pk_mul_f32 v[20:21], v[26:27], v[44:45] op_sel:[0,0] op_sel_hi:[1,0]
    v_pk_fma_f32 v[26:27], v[26:27], v[44:45], v[20:21] op_sel:[1,1,0] op_sel_hi:[0,1,1] neg_hi:[0,1,0]
    v_pk_mul_f32 v[20:21], v[32:33], v[46:47] op_sel:[0,0] op_sel_hi:[1,0]
    v_pk_fma_f32 v[32:33], v[32:33], v[46:47], v[20:21] op_sel:[1,1,0] op_sel_hi:[0,1,1] neg_hi:[0,1,0]
    v_pk_add_f32 v[20:21], v[22:23], v[32:33] neg_lo:[0,1] neg_hi:[0,1]
    v_pk_add_f32 v[22:23], v[22:23], v[32:33]
    v_pk_add_f32 v[32:33], v[36:37], v[26:27] neg_lo:[0,1] neg_hi:[0,1]
    v_pk_add_f32 v[36:37], v[36:37], v[26:27]
    v_pk_fma_f32 v[26:27], v[22:23], s[42:43], v[34:35] op_sel_hi:[1,0,1]
    v_pk_fma_f32 v[28:29], v[22:23], s[44:45], v[34:35] op_sel_hi:[1,0,1]
    v_pk_fma_f32 v[26:27], v[36:37], s[44:45], v[26:27] op_sel_hi:[1,0,1]
    v_pk_fma_f32 v[28:29], v[36:37], s[42:43], v[28:29] op_sel_hi:[1,0,1]
    v_pk_add_f32 v[34:35], v[34:35], v[22:23]
    v_pk_add_f32 v[34:35], v[34:35], v[36:37]
    v_pk_mul_f32 v[22:23], v[20:21], s[46:47] op_sel_hi:[1,0]
    v_pk_mul_f32 v[36:37], v[20:21], s[48:49] op_sel_hi:[1,0]
    v_pk_fma_f32 v[22:23], v[32:33], s[48:49], v[22:23] op_sel_hi:[1,0,1]
    v_pk_fma_f32 v[36:37], v[32:33], s[46:47], v[36:37] op_sel_hi:[1,0,1] neg_lo:[1,0,0] neg_hi:[1,0,0]
    v_pk_add_f32 v[20:21], v[26:27], v[22:23] op_sel:[0,1] op_sel_hi:[1,0] neg_hi:[0,1]
    v_pk_add_f32 v[26:27], v[26:27], v[22:23] op_sel:[0,1] op_sel_hi:[1,0] neg_lo:[0,1]
    v_pk_add_f32 v[32:33], v[28:29], v[36:37] op_sel:[0,1] op_sel_hi:[1,0] neg_hi:[0,1]
    v_pk_add_f32 v[28:29], v[28:29], v[36:37] op_sel:[0,1] op_sel_hi:[1,0] neg_lo:[0,1]
    s_waitcnt vmcnt(0)
    v_pk_mul_f32 v[34:35], v[34:35], s[52:53] op_sel_hi:[1,0]
    v_cvt_pk_bf16_f32 v35, v34, v35
    v_lshlrev_b32 v34, 16, v35
    v_and_b32 v35, 0xffff0000, v35
    v_lshlrev_b32 v36, 16, v84
    v_and_b32 v37, 0xffff0000, v84
    v_pk_add_f32 v[34:35], v[34:35], v[36:37]
    v_cvt_pk_bf16_f32 v84, v34, v35
    v_lshlrev_b32 v34, 16, v84
    v_and_b32 v35, 0xffff0000, v84
    buffer_store_dword v84, v3, s[24:27], s13 offen offset:0
    v_pk_mul_f32 v[26:27], v[26:27], s[52:53] op_sel_hi:[1,0]
    v_cvt_pk_bf16_f32 v27, v26, v27
    v_lshlrev_b32 v26, 16, v27
    v_and_b32 v27, 0xffff0000, v27
    v_lshlrev_b32 v36, 16, v85
    v_and_b32 v37, 0xffff0000, v85
    v_pk_add_f32 v[26:27], v[26:27], v[36:37]
    v_cvt_pk_bf16_f32 v85, v26, v27
    v_lshlrev_b32 v26, 16, v85
    v_and_b32 v27, 0xffff0000, v85
    buffer_store_dword v85, v3, s[24:27], s13 offen offset:256
    v_pk_mul_f32 v[28:29], v[28:29], s[52:53] op_sel_hi:[1,0]
    v_cvt_pk_bf16_f32 v29, v28, v29
    v_lshlrev_b32 v28, 16, v29
    v_and_b32 v29, 0xffff0000, v29
    v_lshlrev_b32 v36, 16, v86
    v_and_b32 v37, 0xffff0000, v86
    v_pk_add_f32 v[28:29], v[28:29], v[36:37]
    v_cvt_pk_bf16_f32 v86, v28, v29
    v_lshlrev_b32 v28, 16, v86
    v_and_b32 v29, 0xffff0000, v86
    buffer_store_dword v86, v3, s[24:27], s13 offen offset:512
    v_pk_mul_f32 v[32:33], v[32:33], s[52:53] op_sel_hi:[1,0]
    v_cvt_pk_bf16_f32 v33, v32, v33
    v_lshlrev_b32 v32, 16, v33
    v_and_b32 v33, 0xffff0000, v33
    v_lshlrev_b32 v36, 16, v87
    v_and_b32 v37, 0xffff0000, v87
    v_pk_add_f32 v[32:33], v[32:33], v[36:37]
    v_cvt_pk_bf16_f32 v87, v32, v33
    v_lshlrev_b32 v32, 16, v87
    v_and_b32 v33, 0xffff0000, v87
    buffer_store_dword v87, v3, s[24:27], s13 offen offset:768
    v_pk_mul_f32 v[20:21], v[20:21], s[52:53] op_sel_hi:[1,0]
    v_cvt_pk_bf16_f32 v21, v20, v21
    v_lshlrev_b32 v20, 16, v21
    v_and_b32 v21, 0xffff0000, v21
    v_lshlrev_b32 v36, 16, v88
    v_and_b32 v37, 0xffff0000, v88
    v_pk_add_f32 v[20:21], v[20:21], v[36:37]
    v_cvt_pk_bf16_f32 v88, v20, v21
    v_lshlrev_b32 v20, 16, v88
    v_and_b32 v21, 0xffff0000, v88
    buffer_store_dword v88, v3, s[24:27], s13 offen offset:1024
    v_pk_add_f32 v[40:41], v[34:35], v[26:27]
    v_pk_add_f32 v[42:43], v[28:29], v[32:33]
    v_pk_add_f32 v[40:41], v[40:41], v[20:21]
    v_pk_add_f32 v[40:41], v[40:41], v[42:43]
    v_add_f32 v40, v40, v41
    s_nop 1
    v_add_f32_dpp v40, v40, v40 quad_perm:[1,0,3,2] row_mask:0xf bank_mask:0xf
    s_nop 1
    v_add_f32_dpp v40, v40, v40 quad_perm:[2,3,0,1] row_mask:0xf bank_mask:0xf
    s_nop 1
    v_add_f32_dpp v40, v40, v40 row_half_mirror row_mask:0xf bank_mask:0xf
    s_nop 1
    v_add_f32_dpp v40, v40, v40 row_mirror row_mask:0xf bank_mask:0xf
    s_nop 1
    v_add_f32_dpp v40, v40, v40 row_bcast:15 row_mask:0xa bank_mask:0xf
    s_nop 1
    v_add_f32_dpp v40, v40, v40 row_bcast:31 row_mask:0xc bank_mask:0xf
    s_nop 1
    v_readlane_b32 s38, v40, 63
    s_nop 1
    v_mov_b32 v46, s50
    v_mul_f32 v46, s38, v46
    v_mov_b32 v47, v46
    v_pk_add_f32 v[42:43], v[34:35], v[46:47] neg_lo:[0,1] neg_hi:[0,1]
    v_pk_mul_f32 v[40:41], v[42:43], v[42:43]
    v_pk_add_f32 v[42:43], v[26:27], v[46:47] neg_lo:[0,1] neg_hi:[0,1]
    v_pk_fma_f32 v[40:41], v[42:43], v[42:43], v[40:41]
    v_pk_add_f32 v[42:43], v[28:29], v[46:47] neg_lo:[0,1] neg_hi:[0,1]
    v_pk_fma_f32 v[40:41], v[42:43], v[42:43], v[40:41]
    v_pk_add_f32 v[42:43], v[32:33], v[46:47] neg_lo:[0,1] neg_hi:[0,1]
    v_pk_fma_f32 v[40:41], v[42:43], v[42:43], v[40:41]
    v_pk_add_f32 v[42:43], v[20:21], v[46:47] neg_lo:[0,1] neg_hi:[0,1]
    v_pk_fma_f32 v[40:41], v[42:43], v[42:43], v[40:41]
    v_add_f32 v40, v40, v41
    s_nop 1
    v_add_f32_dpp v40, v40, v40 quad_perm:[1,0,3,2] row_mask:0xf bank_mask:0xf
    s_nop 1
    v_add_f32_dpp v40, v40, v40 quad_perm:[2,3,0,1] row_mask:0xf bank_mask:0xf
    s_nop 1
    v_add_f32_dpp v40, v40, v40 row_half_mirror row_mask:0xf bank_mask:0xf
    s_nop 1
    v_add_f32_dpp v40, v40, v40 row_mirror row_mask:0xf bank_mask:0xf
    s_nop 1
    v_add_f32_dpp v40, v40, v40 row_bcast:15 row_mask:0xa bank_mask:0xf
    s_nop 1
    v_add_f32_dpp v40, v40, v40 row_bcast:31 row_mask:0xc bank_mask:0xf
    s_nop 1
    v_readlane_b32 s38, v40, 63
    s_nop 1
    v_mov_b32 v44, s50
    v_mul_f32 v44, s38, v44
    v_cvt_pk_bf16_f32 v44, v44, v46
    v_and_b32 v46, 0xffff0000, v44
    v_mov_b32 v47, v46
    v_lshlrev_b32 v44, 16, v44
    v_add_f32 v44, 0x3727c5ac, v44
    v_cvt_pk_bf16_f32 v44, v44, v44
    v_lshlrev_b32 v44, 16, v44
    v_sqrt_f32 v44, v44
    s_nop 0
    v_cvt_pk_bf16_f32 v44, v44, v44
    v_lshlrev_b32 v44, 16, v44
    v_rcp_f32 v45, v44
    s_nop 0
    v_fma_f32 v44, -v44, v45, 2.0
    v_mul_f32 v44, v44, v45
    v_mov_b32 v45, v44
    v_pk_add_f32 v[34:35], v[34:35], v[46:47] neg_lo:[0,1] neg_hi:[0,1]
    v_cvt_pk_bf16_f32 v35, v34, v35
    v_lshlrev_b32 v34, 16, v35
    v_and_b32 v35, 0xffff0000, v35
    v_pk_mul_f32 v[34:35], v[34:35], v[44:45]
    v_cvt_pk_bf16_f32 v48, v34, v35
    v_lshlrev_b32 v34, 16, v48
    v_and_b32 v35, 0xffff0000, v48
    v_pk_add_f32 v[26:27], v[26:27], v[46:47] neg_lo:[0,1] neg_hi:[0,1]
    v_cvt_pk_bf16_f32 v27, v26, v27
    v_lshlrev_b32 v26, 16, v27
    v_and_b32 v27, 0xffff0000, v27
    v_pk_mul_f32 v[26:27], v[26:27], v[44:45]
    v_cvt_pk_bf16_f32 v49, v26, v27
    v_lshlrev_b32 v26, 16, v49
    v_and_b32 v27, 0xffff0000, v49
    v_pk_add_f32 v[28:29], v[28:29], v[46:47] neg_lo:[0,1] neg_hi:[0,1]
    v_cvt_pk_bf16_f32 v29, v28, v29
    v_lshlrev_b32 v28, 16, v29
    v_and_b32 v29, 0xffff0000, v29
    v_pk_mul_f32 v[28:29], v[28:29], v[44:45]
    v_cvt_pk_bf16_f32 v50, v28, v29
    v_lshlrev_b32 v28, 16, v50
    v_and_b32 v29, 0xffff0000, v50
    v_pk_add_f32 v[32:33], v[32:33], v[46:47] neg_lo:[0,1] neg_hi:[0,1]
    v_cvt_pk_bf16_f32 v33, v32, v33
    v_lshlrev_b32 v32, 16, v33
    v_and_b32 v33, 0xffff0000, v33
    v_pk_mul_f32 v[32:33], v[32:33], v[44:45]
    v_cvt_pk_bf16_f32 v51, v32, v33
    v_lshlrev_b32 v32, 16, v51
    v_and_b32 v33, 0xffff0000, v51
    v_pk_add_f32 v[20:21], v[20:21], v[46:47] neg_lo:[0,1] neg_hi:[0,1]
    v_cvt_pk_bf16_f32 v21, v20, v21
    v_lshlrev_b32 v20, 16, v21
    v_and_b32 v21, 0xffff0000, v21
    v_pk_mul_f32 v[20:21], v[20:21], v[44:45]
    v_cvt_pk_bf16_f32 v52, v20, v21
    v_lshlrev_b32 v20, 16, v52
    v_and_b32 v21, 0xffff0000, v52
    v_add_u32 v60, s14, v3
    ds_write_b32 v60, v48 offset:0
    ds_write_b32 v60, v49 offset:256
    ds_write_b32 v60, v50 offset:512
    ds_write_b32 v60, v51 offset:768
    ds_write_b32 v60, v52 offset:1024
    v_lshrrev_b32 v61, 3, v0
    v_and_b32 v62, 7, v0
    v_mul_u32_u24 v63, 2880, v62
    v_lshl_add_u32 v63, v61, 4, v63
    v_lshrrev_b32 v64, 1, v61
    v_lshlrev_b32 v64, 10, v64
    v_and_b32 v65, 1, v61
    v_lshl_add_u32 v64, v65, 9, v64
    v_lshl_add_u32 v64, v62, 4, v64
    s_lshr_b32 s36, s51, 2
    s_mul_i32 s36, s36, 40960
    s_and_b32 s37, s51, 3
    s_lshl_b32 s37, s37, 7
    s_add_u32 s36, s36, s37
    s_add_u32 s37, s36, 32768
    s_waitcnt lgkmcnt(0)
    s_barrier
    ds_read_b128 v[8:11], v63
    ds_read_b128 v[12:15], v63 offset:1024
    s_waitcnt lgkmcnt(1)
    buffer_store_dwordx4 v[8:11], v64, s[28:31], s36 offen
    v_cmp_gt_u32 vcc, 128, v0
    s_and_saveexec_b64 s[32:33], vcc
    s_waitcnt lgkmcnt(0)
    buffer_store_dwordx4 v[12:15], v64, s[28:31], s37 offen
    s_mov_b64 exec, s[32:33]
    s_endpgm
L_k3pf_10:
    s_load_dwordx2 s[6:7], s[0:1], 72
    v_and_b32 v1, 63, v0
    v_lshrrev_b32 v2, 6, v0
    s_nop 0
    v_readfirstlane_b32 s3, v2
    s_cmp_ge_u32 s2, 256
    s_cbranch_scc1 L_k3rl_11
    s_and_b32 s12, s2, 1
    s_lshl_b32 s12, s12, 3
    s_sub_u32 s13, s2, 256
    s_lshr_b32 s13, s13, 3
    s_add_u32 s12, s12, s13
    s_mul_i32 s12, s12, 245760
    s_mul_i32 s13, s3, 30720
    s_add_u32 s12, s12, s13
    v_lshlrev_b32 v3, 6, v1
    s_waitcnt lgkmcnt(0)
    s_add_u32 s16, s6, 0x1800000
    s_addc_u32 s17, s7, 0
    s_and_b32 s17, s17, 0xffff
    s_mov_b32 s18, 0x3c0000
    s_mov_b32 s19, 0x00020000
    buffer_load_dword v4, v3, s[16:19], s12 offen
    s_add_u32 s12, s12, 4096
    buffer_load_dword v5, v3, s[16:19], s12 offen
    s_add_u32 s12, s12, 4096
    buffer_load_dword v6, v3, s[16:19], s12 offen
    s_add_u32 s12, s12, 4096
    buffer_load_dword v7, v3, s[16:19], s12 offen
    s_add_u32 s12, s12, 4096
    buffer_load_dword v8, v3, s[16:19], s12 offen
    s_add_u32 s12, s12, 4096
    buffer_load_dword v9, v3, s[16:19], s12 offen
    s_add_u32 s12, s12, 4096
    buffer_load_dword v10, v3, s[16:19], s12 offen
    s_add_u32 s12, s12, 2048
    buffer_load_dword v11, v3, s[16:19], s12 offen
    s_add_u32 s12, s12, 2048
    s_endpgm
L_k3rl_11:
L_k3end_9:
    s_endpgm
.globl k4_kernel
.p2align 8
.type k4_kernel,@function
k4_kernel:
    s_cmp_ge_u32 s2, 256
    s_cbranch_scc1 L_k4end_12
    s_load_dwordx2 s[6:7], s[0:1], 72
    v_and_b32 v1, 63, v0
    v_lshrrev_b32 v2, 6, v0
    s_nop 0
    v_readfirstlane_b32 s3, v2
    s_and_b32 s13, s2, 7
    s_lshr_b32 s14, s2, 3
    s_and_b32 s8, s13, 1
    s_lshl_b32 s8, s8, 3
    s_and_b32 s15, s14, 7
    s_add_u32 s8, s8, s15
    s_lshr_b32 s9, s13, 1
    s_lshl_b32 s9, s9, 2
    s_lshr_b32 s15, s14, 3
    s_add_u32 s9, s9, s15
    s_and_b32 s10, s3, 3
    s_lshr_b32 s11, s3, 2
    s_lshr_b32 s30, s3, 2
    v_lshlrev_b32 v3, 4, v1
    s_lshr_b32 s13, s3, 1
    s_and_b32 s14, s3, 1
    s_lshl_b32 s14, s14, 10
    s_lshl_b32 s15, s9, 2
    s_add_u32 s15, s15, s13
    s_mul_i32 s20, s15, 40960
    s_add_u32 s20, s20, s14
    s_add_u32 s20, s20, 0x1400000
    s_mul_i32 s15, s8, 6
    s_add_u32 s15, s15, s13
    s_mul_i32 s21, s15, 40960
    s_add_u32 s21, s21, s14
    s_add_u32 s21, s21, 0x1800000
    s_add_u32 s22, s21, 163840
    s_lshl_b32 s12, s3, 10
    s_lshl_b32 s13, s10, 11
    v_add_u32 v5, s13, v3
    v_add_u32 v6, 61440, v5
    s_mul_i32 s13, s11, 6144
    s_add_u32 s13, s13, 8192
    v_add_u32 v8, s13, v3
    v_add_u32 v9, 61440, v8
    v_lshlrev_b32 v14, 6, v1
    s_and_b32 s31, s2, 1
    s_mul_i32 s31, s31, 983040
    s_lshr_b32 s13, s2, 3
    s_mul_i32 s13, s13, 30720
    s_add_u32 s31, s31, s13
    s_lshl_b32 s13, s3, 12
    s_add_u32 s31, s31, s13
    s_add_u32 s31, s31, 0x1c00000
    s_waitcnt lgkmcnt(0)
    s_mov_b32 s16, s6
    s_and_b32 s17, s7, 0xffff
    s_mov_b32 s18, 0x10000000
    s_mov_b32 s19, 0x00020000
    s_cmp_eq_u32 s30, 1
    s_cbranch_scc1 L_k4g1_13
    s_add_u32 m0, s12, 0
    s_nop 0
    buffer_load_dwordx4 v3, s[16:19], s20 offen lds
    s_add_u32 s20, s20, 2048
    s_add_u32 m0, s12, 8192
    s_nop 0
    buffer_load_dwordx4 v3, s[16:19], s21 offen lds
    s_add_u32 s21, s21, 2048
    s_add_u32 m0, s12, 16384
    s_nop 0
    buffer_load_dwordx4 v3, s[16:19], s22 offen lds
    s_add_u32 s22, s22, 2048
    s_add_u32 m0, s12, 20480
    s_nop 0
    buffer_load_dwordx4 v3, s[16:19], s20 offen lds
    s_add_u32 s20, s20, 2048
    s_add_u32 m0, s12, 28672
    s_nop 0
    buffer_load_dwordx4 v3, s[16:19], s21 offen lds
    s_add_u32 s21, s21, 2048
    s_add_u32 m0, s12, 36864
    s_nop 0
    buffer_load_dwordx4 v3, s[16:19], s22 offen lds
    s_add_u32 s22, s22, 2048
    s_add_u32 m0, s12, 40960
    s_nop 0
    buffer_load_dwordx4 v3, s[16:19], s20 offen lds
    s_add_u32 s20, s20, 2048
    s_add_u32 m0, s12, 49152
    s_nop 0
    buffer_load_dwordx4 v3, s[16:19], s21 offen lds
    s_add_u32 s21, s21, 2048
    s_add_u32 m0, s12, 57344
    s_nop 0
    buffer_load_dwordx4 v3, s[16:19], s22 offen lds
    s_add_u32 s22, s22, 2048
    s_waitcnt vmcnt(6)
    s_barrier
    ds_read_b128 v[16:19], v5 offset:0
    ds_read_b128 v[20:23], v8 offset:0
    ds_read_b128 v[24:27], v8 offset:2048
    ds_read_b128 v[28:31], v8 offset:4096
    ds_read_b128 v[32:35], v5 offset:1024
    ds_read_b128 v[36:39], v8 offset:1024
    ds_read_b128 v[40:43], v8 offset:3072
    ds_read_b128 v[44:47], v8 offset:5120
    s_add_u32 m0, s12, 61440
    s_nop 0
    buffer_load_dwordx4 v3, s[16:19], s20 offen lds
    s_add_u32 s20, s20, 2048
    s_add_u32 m0, s12, 69632
    s_nop 0
    buffer_load_dwordx4 v3, s[16:19], s21 offen lds
    s_add_u32 s21, s21, 2048
    s_add_u32 m0, s12, 77824
    s_nop 0
    buffer_load_dwordx4 v3, s[16:19], s22 offen lds
    s_add_u32 s22, s22, 2048
    s_add_u32 m0, s12, 81920
    s_nop 0
    buffer_load_dwordx4 v3, s[16:19], s20 offen lds
    s_add_u32 s20, s20, 2048
    s_add_u32 m0, s12, 90112
    s_nop 0
    buffer_load_dwordx4 v3, s[16:19], s21 offen lds
    s_add_u32 s21, s21, 2048
    s_add_u32 m0, s12, 98304
    s_nop 0
    buffer_load_dwordx4 v3, s[16:19], s22 offen lds
    s_add_u32 s22, s22, 2048
    s_waitcnt vmcnt(9) lgkmcnt(0)
    s_barrier
    v_mfma_f32_32x32x16_bf16 v[80:95], v[20:23], v[16:19], 0
    ds_read_b128 v[48:51], v5 offset:20480
    ds_read_b128 v[52:55], v8 offset:20480
    v_mfma_f32_32x32x16_bf16 v[96:111], v[24:27], v[16:19], 0
    ds_read_b128 v[56:59], v8 offset:22528
    ds_read_b128 v[60:63], v8 offset:24576
    v_mfma_f32_32x32x16_bf16 v[112:127], v[28:31], v[16:19], 0
    ds_read_b128 v[64:67], v5 offset:21504
    ds_read_b128 v[68:71], v8 offset:21504
    v_mfma_f32_32x32x16_bf16 v[80:95], v[36:39], v[32:35], v[80:95]
    ds_read_b128 v[72:75], v8 offset:23552
    ds_read_b128 v[76:79], v8 offset:25600
    s_add_u32 m0, s12, 102400
    s_nop 0
    buffer_load_dwordx4 v3, s[16:19], s20 offen lds
    s_add_u32 s20, s20, 2048
    v_mfma_f32_32x32x16_bf16 v[96:111], v[40:43], v[32:35], v[96:111]
    s_add_u32 m0, s12, 110592
    s_nop 0
    buffer_load_dwordx4 v3, s[16:19], s21 offen lds
    s_add_u32 s21, s21, 2048
    v_mfma_f32_32x32x16_bf16 v[112:127], v[44:47], v[32:35], v[112:127]
    s_add_u32 m0, s12, 118784
    s_nop 0
    buffer_load_dwordx4 v3, s[16:19], s22 offen lds
    s_add_u32 s22, s22, 2048
    s_waitcnt vmcnt(9) lgkmcnt(0)
    s_barrier
    v_mfma_f32_32x32x16_bf16 v[80:95], v[52:55], v[48:51], v[80:95]
    ds_read_b128 v[16:19], v5 offset:40960
    ds_read_b128 v[20:23], v8 offset:40960
    v_mfma_f32_32x32x16_bf16 v[96:111], v[56:59], v[48:51], v[96:111]
    ds_read_b128 v[24:27], v8 offset:43008
    ds_read_b128 v[28:31], v8 offset:45056
    v_mfma_f32_32x32x16_bf16 v[112:127], v[60:63], v[48:51], v[112:127]
    ds_read_b128 v[32:35], v5 offset:41984
    ds_read_b128 v[36:39], v8 offset:41984
    v_mfma_f32_32x32x16_bf16 v[80:95], v[68:71], v[64:67], v[80:95]
    ds_read_b128 v[40:43], v8 offset:44032
    ds_read_b128 v[44:47], v8 offset:46080
    s_add_u32 m0, s12, 0
    s_nop 0
    buffer_load_dwordx4 v3, s[16:19], s20 offen lds
    s_add_u32 s20, s20, 2048
    v_mfma_f32_32x32x16_bf16 v[96:111], v[72:75], v[64:67], v[96:111]
    s_add_u32 m0, s12, 8192
    s_nop 0
    buffer_load_dwordx4 v3, s[16:19], s21 offen lds
    s_add_u32 s21, s21, 2048
    v_mfma_f32_32x32x16_bf16 v[112:127], v[76:79], v[64:67], v[112:127]
    s_add_u32 m0, s12, 16384
    s_nop 0
    buffer_load_dwordx4 v3, s[16:19], s22 offen lds
    s_add_u32 s22, s22, 2048
    s_waitcnt vmcnt(9) lgkmcnt(0)
    s_barrier
    v_mfma_f32_32x32x16_bf16 v[80:95], v[20:23], v[16:19], v[80:95]
    ds_read_b128 v[48:51], v6 offset:0
    ds_read_b128 v[52:55], v9 offset:0
    v_mfma_f32_32x32x16_bf16 v[96:111], v[24:27], v[16:19], v[96:111]
    ds_read_b128 v[56:59], v9 offset:2048
    ds_read_b128 v[60:63], v9 offset:4096
    v_mfma_f32_32x32x16_bf16 v[112:127], v[28:31], v[16:19], v[112:127]
    ds_read_b128 v[64:67], v6 offset:1024
    ds_read_b128 v[68:71], v9 offset:1024
    v_mfma_f32_32x32x16_bf16 v[80:95], v[36:39], v[32:35], v[80:95]
    ds_read_b128 v[72:75], v9 offset:3072
    ds_read_b128 v[76:79], v9 offset:5120
    s_add_u32 m0, s12, 20480
    s_nop 0
    buffer_load_dwordx4 v3, s[16:19], s20 offen lds
    s_add_u32 s20, s20, 2048
    v_mfma_f32_32x32x16_bf16 v[96:111], v[40:43], v[32:35], v[96:111]
    s_add_u32 m0, s12, 28672
    s_nop 0
    buffer_load_dwordx4 v3, s[16:19], s21 offen lds
    s_add_u32 s21, s21, 2048
    v_mfma_f32_32x32x16_bf16 v[112:127], v[44:47], v[32:35], v[112:127]
    s_add_u32 m0, s12, 36864
    s_nop 0
    buffer_load_dwordx4 v3, s[16:19], s22 offen lds
    s_add_u32 s22, s22, 2048
    s_waitcnt vmcnt(9) lgkmcnt(0)
    s_barrier
    v_mfma_f32_32x32x16_bf16 v[80:95], v[52:55], v[48:51], v[80:95]
    ds_read_b128 v[16:19], v6 offset:20480
    ds_read_b128 v[20:23], v9 offset:20480
    v_mfma_f32_32x32x16_bf16 v[96:111], v[56:59], v[48:51], v[96:111]
    ds_read_b128 v[24:27], v9 offset:22528
    ds_read_b128 v[28:31], v9 offset:24576
    v_mfma_f32_32x32x16_bf16 v[112:127], v[60:63], v[48:51], v[112:127]
    ds_read_b128 v[32:35], v6 offset:21504
    ds_read_b128 v[36:39], v9 offset:21504
    v_mfma_f32_32x32x16_bf16 v[80:95], v[68:71], v[64:67], v[80:95]
    ds_read_b128 v[40:43], v9 offset:23552
    ds_read_b128 v[44:47], v9 offset:25600
    s_add_u32 m0, s12, 40960
    s_nop 0
    buffer_load_dwordx4 v3, s[16:19], s20 offen lds
    s_add_u32 s20, s20, 2048
    v_mfma_f32_32x32x16_bf16 v[96:111], v[72:75], v[64:67], v[96:111]
    s_add_u32 m0, s12, 49152
    s_nop 0
    buffer_load_dwordx4 v3, s[16:19], s21 offen lds
    s_add_u32 s21, s21, 2048
    v_mfma_f32_32x32x16_bf16 v[112:127], v[76:79], v[64:67], v[112:127]
    s_add_u32 m0, s12, 57344
    s_nop 0
    buffer_load_dwordx4 v3, s[16:19], s22 offen lds
    s_add_u32 s22, s22, 2048
    s_waitcnt vmcnt(9) lgkmcnt(0)
    s_barrier
    v_mfma_f32_32x32x16_bf16 v[80:95], v[20:23], v[16:19], v[80:95]
    ds_read_b128 v[48:51], v6 offset:40960
    ds_read_b128 v[52:55], v9 offset:40960
    v_mfma_f32_32x32x16_bf16 v[96:111], v[24:27], v[16:19], v[96:111]
    ds_read_b128 v[56:59], v9 offset:43008
    ds_read_b128 v[60:63], v9 offset:45056
    v_mfma_f32_32x32x16_bf16 v[112:127], v[28:31], v[16:19], v[112:127]
    ds_read_b128 v[64:67], v6 offset:41984
    ds_read_b128 v[68:71], v9 offset:41984
    v_mfma_f32_32x32x16_bf16 v[80:95], v[36:39], v[32:35], v[80:95]
    ds_read_b128 v[72:75], v9 offset:44032
    ds_read_b128 v[76:79], v9 offset:46080
    s_add_u32 m0, s12, 61440
    s_nop 0
    buffer_load_dwordx4 v3, s[16:19], s20 offen lds
    s_add_u32 s20, s20, 2048
    v_mfma_f32_32x32x16_bf16 v[96:111], v[40:43], v[32:35], v[96:111]
    s_add_u32 m0, s12, 69632
    s_nop 0
    buffer_load_dwordx4 v3, s[16:19], s21 offen lds
    s_add_u32 s21, s21, 2048
    v_mfma_f32_32x32x16_bf16 v[112:127], v[44:47], v[32:35], v[112:127]
    s_add_u32 m0, s12, 77824
    s_nop 0
    buffer_load_dwordx4 v3, s[16:19], s22 offen lds
    s_add_u32 s22, s22, 2048
    s_waitcnt vmcnt(9) lgkmcnt(0)
    s_barrier
    v_mfma_f32_32x32x16_bf16 v[80:95], v[52:55], v[48:51], v[80:95]
    ds_read_b128 v[16:19], v5 offset:0
    ds_read_b128 v[20:23], v8 offset:0
    v_mfma_f32_32x32x16_bf16 v[96:111], v[56:59], v[48:51], v[96:111]
    ds_read_b128 v[24:27], v8 offset:2048
    ds_read_b128 v[28:31], v8 offset:4096
    v_mfma_f32_32x32x16_bf16 v[112:127], v[60:63], v[48:51], v[112:127]
    ds_read_b128 v[32:35], v5 offset:1024
    ds_read_b128 v[36:39], v8 offset:1024
    v_mfma_f32_32x32x16_bf16 v[80:95], v[68:71], v[64:67], v[80:95]
    ds_read_b128 v[40:43], v8 offset:3072
    ds_read_b128 v[44:47], v8 offset:5120
    s_add_u32 m0, s12, 81920
    s_nop 0
    buffer_load_dwordx4 v3, s[16:19], s20 offen lds
    s_add_u32 s20, s20, 2048
    v_mfma_f32_32x32x16_bf16 v[96:111], v[72:75], v[64:67], v[96:111]
    s_add_u32 m0, s12, 90112
    s_nop 0
    buffer_load_dwordx4 v3, s[16:19], s21 offen lds
    s_add_u32 s21, s21, 2048
    v_mfma_f32_32x32x16_bf16 v[112:127], v[76:79], v[64:67], v[112:127]
    s_add_u32 m0, s12, 98304
    s_nop 0
    buffer_load_dwordx4 v3, s[16:19], s22 offen lds
    s_add_u32 s22, s22, 2048
    s_waitcnt vmcnt(9) lgkmcnt(0)
    s_barrier
    v_mfma_f32_32x32x16_bf16 v[80:95], v[20:23], v[16:19], v[80:95]
    ds_read_b128 v[48:51], v5 offset:20480
    ds_read_b128 v[52:55], v8 offset:20480
    v_mfma_f32_32x32x16_bf16 v[96:111], v[24:27], v[16:19], v[96:111]
    ds_read_b128 v[56:59], v8 offset:22528
    ds_read_b128 v[60:63], v8 offset:24576
    v_mfma_f32_32x32x16_bf16 v[112:127], v[28:31], v[16:19], v[112:127]
    ds_read_b128 v[64:67], v5 offset:21504
    ds_read_b128 v[68:71], v8 offset:21504
    v_mfma_f32_32x32x16_bf16 v[80:95], v[36:39], v[32:35], v[80:95]
    ds_read_b128 v[72:75], v8 offset:23552
    ds_read_b128 v[76:79], v8 offset:25600
    s_add_u32 m0, s12, 102400
    s_nop 0
    buffer_load_dwordx4 v3, s[16:19], s20 offen lds
    s_add_u32 s20, s20, 2048
    v_mfma_f32_32x32x16_bf16 v[96:111], v[40:43], v[32:35], v[96:111]
    s_add_u32 m0, s12, 110592
    s_nop 0
    buffer_load_dwordx4 v3, s[16:19], s21 offen lds
    s_add_u32 s21, s21, 2048
    v_mfma_f32_32x32x16_bf16 v[112:127], v[44:47], v[32:35], v[112:127]
    s_add_u32 m0, s12, 118784
    s_nop 0
    buffer_load_dwordx4 v3, s[16:19], s22 offen lds
    s_add_u32 s22, s22, 2048
    s_waitcnt vmcnt(9) lgkmcnt(0)
    s_barrier
    v_mfma_f32_32x32x16_bf16 v[80:95], v[52:55], v[48:51], v[80:95]
    ds_read_b128 v[16:19], v5 offset:40960
    ds_read_b128 v[20:23], v8 offset:40960
    v_mfma_f32_32x32x16_bf16 v[96:111], v[56:59], v[48:51], v[96:111]
    ds_read_b128 v[24:27], v8 offset:43008
    ds_read_b128 v[28:31], v8 offset:45056
    v_mfma_f32_32x32x16_bf16 v[112:127], v[60:63], v[48:51], v[112:127]
    ds_read_b128 v[32:35], v5 offset:41984
    ds_read_b128 v[36:39], v8 offset:41984
    v_mfma_f32_32x32x16_bf16 v[80:95], v[68:71], v[64:67], v[80:95]
    ds_read_b128 v[40:43], v8 offset:44032
    ds_read_b128 v[44:47], v8 offset:46080
    s_add_u32 m0, s12, 0
    s_nop 0
    buffer_load_dwordx4 v3, s[16:19], s20 offen lds
    s_add_u32 s20, s20, 2048
    v_mfma_f32_32x32x16_bf16 v[96:111], v[72:75], v[64:67], v[96:111]
    s_add_u32 m0, s12, 8192
    s_nop 0
    buffer_load_dwordx4 v3, s[16:19], s21 offen lds
    s_add_u32 s21, s21, 2048
    v_mfma_f32_32x32x16_bf16 v[112:127], v[76:79], v[64:67], v[112:127]
    s_add_u32 m0, s12, 16384
    s_nop 0
    buffer_load_dwordx4 v3, s[16:19], s22 offen lds
    s_add_u32 s22, s22, 2048
    s_waitcnt vmcnt(9) lgkmcnt(0)
    s_barrier
    v_mfma_f32_32x32x16_bf16 v[80:95], v[20:23], v[16:19], v[80:95]
    ds_read_b128 v[48:51], v6 offset:0
    ds_read_b128 v[52:55], v9 offset:0
    v_mfma_f32_32x32x16_bf16 v[96:111], v[24:27], v[16:19], v[96:111]
    ds_read_b128 v[56:59], v9 offset:2048
    ds_read_b128 v[60:63], v9 offset:4096
    v_mfma_f32_32x32x16_bf16 v[112:127], v[28:31], v[16:19], v[112:127]
    ds_read_b128 v[64:67], v6 offset:1024
    ds_read_b128 v[68:71], v9 offset:1024
    v_mfma_f32_32x32x16_bf16 v[80:95], v[36:39], v[32:35], v[80:95]
    ds_read_b128 v[72:75], v9 offset:3072
    ds_read_b128 v[76:79], v9 offset:5120
    s_add_u32 m0, s12, 20480
    s_nop 0
    buffer_load_dwordx4 v3, s[16:19], s20 offen lds
    s_add_u32 s20, s20, 2048
    v_mfma_f32_32x32x16_bf16 v[96:111], v[40:43], v[32:35], v[96:111]
    s_add_u32 m0, s12, 28672
    s_nop 0
    buffer_load_dwordx4 v3, s[16:19], s21 offen lds
    s_add_u32 s21, s21, 2048
    v_mfma_f32_32x32x16_bf16 v[112:127], v[44:47], v[32:35], v[112:127]
    s_add_u32 m0, s12, 36864
    s_nop 0
    buffer_load_dwordx4 v3, s[16:19], s22 offen lds
    s_add_u32 s22, s22, 2048
    s_waitcnt vmcnt(9) lgkmcnt(0)
    s_barrier
    v_mfma_f32_32x32x16_bf16 v[80:95], v[52:55], v[48:51], v[80:95]
    ds_read_b128 v[16:19], v6 offset:20480
    ds_read_b128 v[20:23], v9 offset:20480
    v_mfma_f32_32x32x16_bf16 v[96:111], v[56:59], v[48:51], v[96:111]
    ds_read_b128 v[24:27], v9 offset:22528
    ds_read_b128 v[28:31], v9 offset:24576
    v_mfma_f32_32x32x16_bf16 v[112:127], v[60:63], v[48:51], v[112:127]
    ds_read_b128 v[32:35], v6 offset:21504
    ds_read_b128 v[36:39], v9 offset:21504
    v_mfma_f32_32x32x16_bf16 v[80:95], v[68:71], v[64:67], v[80:95]
    ds_read_b128 v[40:43], v9 offset:23552
    ds_read_b128 v[44:47], v9 offset:25600
    s_add_u32 m0, s12, 40960
    s_nop 0
    buffer_load_dwordx4 v3, s[16:19], s20 offen lds
    s_add_u32 s20, s20, 2048
    v_mfma_f32_32x32x16_bf16 v[96:111], v[72:75], v[64:67], v[96:111]
    s_add_u32 m0, s12, 49152
    s_nop 0
    buffer_load_dwordx4 v3, s[16:19], s21 offen lds
    s_add_u32 s21, s21, 2048
    v_mfma_f32_32x32x16_bf16 v[112:127], v[76:79], v[64:67], v[112:127]
    s_add_u32 m0, s12, 57344
    s_nop 0
    buffer_load_dwordx4 v3, s[16:19], s22 offen lds
    s_add_u32 s22, s22, 2048
    s_waitcnt vmcnt(9) lgkmcnt(0)
    s_barrier
    v_mfma_f32_32x32x16_bf16 v[80:95], v[20:23], v[16:19], v[80:95]
    ds_read_b128 v[48:51], v6 offset:40960
    ds_read_b128 v[52:55], v9 offset:40960
    v_mfma_f32_32x32x16_bf16 v[96:111], v[24:27], v[16:19], v[96:111]
    ds_read_b128 v[56:59], v9 offset:43008
    ds_read_b128 v[60:63], v9 offset:45056
    v_mfma_f32_32x32x16_bf16 v[112:127], v[28:31], v[16:19], v[112:127]
    ds_read_b128 v[64:67], v6 offset:41984
    ds_read_b128 v[68:71], v9 offset:41984
    v_mfma_f32_32x32x16_bf16 v[80:95], v[36:39], v[32:35], v[80:95]
    ds_read_b128 v[72:75], v9 offset:44032
    ds_read_b128 v[76:79], v9 offset:46080
    s_add_u32 m0, s12, 61440
    s_nop 0
    buffer_load_dwordx4 v3, s[16:19], s20 offen lds
    s_add_u32 s20, s20, 2048
    v_mfma_f32_32x32x16_bf16 v[96:111], v[40:43], v[32:35], v[96:111]
    s_add_u32 m0, s12, 69632
    s_nop 0
    buffer_load_dwordx4 v3, s[16:19], s21 offen lds
    s_add_u32 s21, s21, 2048
    v_mfma_f32_32x32x16_bf16 v[112:127], v[44:47], v[32:35], v[112:127]
    s_add_u32 m0, s12, 77824
    s_nop 0
    buffer_load_dwordx4 v3, s[16:19], s22 offen lds
    s_add_u32 s22, s22, 2048
    s_waitcnt vmcnt(9) lgkmcnt(0)
    s_barrier
    v_mfma_f32_32x32x16_bf16 v[80:95], v[52:55], v[48:51], v[80:95]
    ds_read_b128 v[16:19], v5 offset:0
    ds_read_b128 v[20:23], v8 offset:0
    v_mfma_f32_32x32x16_bf16 v[96:111], v[56:59], v[48:51], v[96:111]
    ds_read_b128 v[24:27], v8 offset:2048
    ds_read_b128 v[28:31], v8 offset:4096
    v_mfma_f32_32x32x16_bf16 v[112:127], v[60:63], v[48:51], v[112:127]
    ds_read_b128 v[32:35], v5 offset:1024
    ds_read_b128 v[36:39], v8 offset:1024
    v_mfma_f32_32x32x16_bf16 v[80:95], v[68:71], v[64:67], v[80:95]
    ds_read_b128 v[40:43], v8 offset:3072
    ds_read_b128 v[44:47], v8 offset:5120
    s_add_u32 m0, s12, 81920
    s_nop 0
    buffer_load_dwordx4 v3, s[16:19], s20 offen lds
    s_add_u32 s20, s20, 2048
    v_mfma_f32_32x32x16_bf16 v[96:111], v[72:75], v[64:67], v[96:111]
    s_add_u32 m0, s12, 90112
    s_nop 0
    buffer_load_dwordx4 v3, s[16:19], s21 offen lds
    s_add_u32 s21, s21, 2048
    v_mfma_f32_32x32x16_bf16 v[112:127], v[76:79], v[64:67], v[112:127]
    s_add_u32 m0, s12, 98304
    s_nop 0
    buffer_load_dwordx4 v3, s[16:19], s22 offen lds
    s_add_u32 s22, s22, 2048
    s_waitcnt vmcnt(9) lgkmcnt(0)
    s_barrier
    v_mfma_f32_32x32x16_bf16 v[80:95], v[20:23], v[16:19], v[80:95]
    ds_read_b128 v[48:51], v5 offset:20480
    ds_read_b128 v[52:55], v8 offset:20480
    v_mfma_f32_32x32x16_bf16 v[96:111], v[24:27], v[16:19], v[96:111]
    ds_read_b128 v[56:59], v8 offset:22528
    ds_read_b128 v[60:63], v8 offset:24576
    v_mfma_f32_32x32x16_bf16 v[112:127], v[28:31], v[16:19], v[112:127]
    ds_read_b128 v[64:67], v5 offset:21504
    ds_read_b128 v[68:71], v8 offset:21504
    v_mfma_f32_32x32x16_bf16 v[80:95], v[36:39], v[32:35], v[80:95]
    ds_read_b128 v[72:75], v8 offset:23552
    ds_read_b128 v[76:79], v8 offset:25600
    s_add_u32 m0, s12, 102400
    s_nop 0
    buffer_load_dwordx4 v3, s[16:19], s20 offen lds
    s_add_u32 s20, s20, 2048
    v_mfma_f32_32x32x16_bf16 v[96:111], v[40:43], v[32:35], v[96:111]
    s_add_u32 m0, s12, 110592
    s_nop 0
    buffer_load_dwordx4 v3, s[16:19], s21 offen lds
    s_add_u32 s21, s21, 2048
    v_mfma_f32_32x32x16_bf16 v[112:127], v[44:47], v[32:35], v[112:127]
    s_add_u32 m0, s12, 118784
    s_nop 0
    buffer_load_dwordx4 v3, s[16:19], s22 offen lds
    s_add_u32 s22, s22, 2048
    s_waitcnt vmcnt(9) lgkmcnt(0)
    s_barrier
    v_mfma_f32_32x32x16_bf16 v[80:95], v[52:55], v[48:51], v[80:95]
    ds_read_b128 v[16:19], v5 offset:40960
    ds_read_b128 v[20:23], v8 offset:40960
    v_mfma_f32_32x32x16_bf16 v[96:111], v[56:59], v[48:51], v[96:111]
    ds_read_b128 v[24:27], v8 offset:43008
    ds_read_b128 v[28:31], v8 offset:45056
    v_mfma_f32_32x32x16_bf16 v[112:127], v[60:63], v[48:51], v[112:127]
    ds_read_b128 v[32:35], v5 offset:41984
    ds_read_b128 v[36:39], v8 offset:41984
    v_mfma_f32_32x32x16_bf16 v[80:95], v[68:71], v[64:67], v[80:95]
    ds_read_b128 v[40:43], v8 offset:44032
    ds_read_b128 v[44:47], v8 offset:46080
    s_add_u32 m0, s12, 0
    s_nop 0
    buffer_load_dwordx4 v3, s[16:19], s20 offen lds
    s_add_u32 s20, s20, 2048
    v_mfma_f32_32x32x16_bf16 v[96:111], v[72:75], v[64:67], v[96:111]
    s_add_u32 m0, s12, 8192
    s_nop 0
    buffer_load_dwordx4 v3, s[16:19], s21 offen lds
    s_add_u32 s21, s21, 2048
    v_mfma_f32_32x32x16_bf16 v[112:127], v[76:79], v[64:67], v[112:127]
    s_add_u32 m0, s12, 16384
    s_nop 0
    buffer_load_dwordx4 v3, s[16:19], s22 offen lds
    s_add_u32 s22, s22, 2048
    s_waitcnt vmcnt(9) lgkmcnt(0)
    s_barrier
    v_mfma_f32_32x32x16_bf16 v[80:95], v[20:23], v[16:19], v[80:95]
    ds_read_b128 v[48:51], v6 offset:0
    ds_read_b128 v[52:55], v9 offset:0
    v_mfma_f32_32x32x16_bf16 v[96:111], v[24:27], v[16:19], v[96:111]
    ds_read_b128 v[56:59], v9 offset:2048
    ds_read_b128 v[60:63], v9 offset:4096
    v_mfma_f32_32x32x16_bf16 v[112:127], v[28:31], v[16:19], v[112:127]
    ds_read_b128 v[64:67], v6 offset:1024
    ds_read_b128 v[68:71], v9 offset:1024
    v_mfma_f32_32x32x16_bf16 v[80:95], v[36:39], v[32:35], v[80:95]
    ds_read_b128 v[72:75], v9 offset:3072
    ds_read_b128 v[76:79], v9 offset:5120
    s_add_u32 m0, s12, 20480
    s_nop 0
    buffer_load_dwordx4 v3, s[16:19], s20 offen lds
    s_add_u32 s20, s20, 2048
    v_mfma_f32_32x32x16_bf16 v[96:111], v[40:43], v[32:35], v[96:111]
    s_add_u32 m0, s12, 28672
    s_nop 0
    buffer_load_dwordx4 v3, s[16:19], s21 offen lds
    s_add_u32 s21, s21, 2048
    v_mfma_f32_32x32x16_bf16 v[112:127], v[44:47], v[32:35], v[112:127]
    s_add_u32 m0, s12, 36864
    s_nop 0
    buffer_load_dwordx4 v3, s[16:19], s22 offen lds
    s_add_u32 s22, s22, 2048
    s_waitcnt vmcnt(9) lgkmcnt(0)
    s_barrier
    v_mfma_f32_32x32x16_bf16 v[80:95], v[52:55], v[48:51], v[80:95]
    ds_read_b128 v[16:19], v6 offset:20480
    ds_read_b128 v[20:23], v9 offset:20480
    v_mfma_f32_32x32x16_bf16 v[96:111], v[56:59], v[48:51], v[96:111]
    ds_read_b128 v[24:27], v9 offset:22528
    ds_read_b128 v[28:31], v9 offset:24576
    v_mfma_f32_32x32x16_bf16 v[112:127], v[60:63], v[48:51], v[112:127]
    ds_read_b128 v[32:35], v6 offset:21504
    ds_read_b128 v[36:39], v9 offset:21504
    v_mfma_f32_32x32x16_bf16 v[80:95], v[68:71], v[64:67], v[80:95]
    ds_read_b128 v[40:43], v9 offset:23552
    ds_read_b128 v[44:47], v9 offset:25600
    v_mfma_f32_32x32x16_bf16 v[96:111], v[72:75], v[64:67], v[96:111]
    buffer_load_dword v128, v14, s[16:19], s31 offen
    v_mfma_f32_32x32x16_bf16 v[112:127], v[76:79], v[64:67], v[112:127]
    s_waitcnt vmcnt(7) lgkmcnt(0)
    s_barrier
    v_mfma_f32_32x32x16_bf16 v[80:95], v[20:23], v[16:19], v[80:95]
    ds_read_b128 v[48:51], v6 offset:40960
    ds_read_b128 v[52:55], v9 offset:40960
    v_mfma_f32_32x32x16_bf16 v[96:111], v[24:27], v[16:19], v[96:111]
    ds_read_b128 v[56:59], v9 offset:43008
    ds_read_b128 v[60:63], v9 offset:45056
    v_mfma_f32_32x32x16_bf16 v[112:127], v[28:31], v[16:19], v[112:127]
    ds_read_b128 v[64:67], v6 offset:41984
    ds_read_b128 v[68:71], v9 offset:41984
    v_mfma_f32_32x32x16_bf16 v[80:95], v[36:39], v[32:35], v[80:95]
    ds_read_b128 v[72:75], v9 offset:44032
    ds_read_b128 v[76:79], v9 offset:46080
    v_mfma_f32_32x32x16_bf16 v[96:111], v[40:43], v[32:35], v[96:111]
    v_mfma_f32_32x32x16_bf16 v[112:127], v[44:47], v[32:35], v[112:127]
    s_waitcnt vmcnt(4) lgkmcnt(0)
    s_barrier
    v_mfma_f32_32x32x16_bf16 v[80:95], v[52:55], v[48:51], v[80:95]
    ds_read_b128 v[16:19], v5 offset:0
    ds_read_b128 v[20:23], v8 offset:0
    v_mfma_f32_32x32x16_bf16 v[96:111], v[56:59], v[48:51], v[96:111]
    ds_read_b128 v[24:27], v8 offset:2048
    ds_read_b128 v[28:31], v8 offset:4096
    v_mfma_f32_32x32x16_bf16 v[112:127], v[60:63], v[48:51], v[112:127]
    ds_read_b128 v[32:35], v5 offset:1024
    ds_read_b128 v[36:39], v8 offset:1024
    v_mfma_f32_32x32x16_bf16 v[80:95], v[68:71], v[64:67], v[80:95]
    ds_read_b128 v[40:43], v8 offset:3072
    ds_read_b128 v[44:47], v8 offset:5120
    v_mfma_f32_32x32x16_bf16 v[96:111], v[72:75], v[64:67], v[96:111]
    v_mfma_f32_32x32x16_bf16 v[112:127], v[76:79], v[64:67], v[112:127]
    s_waitcnt vmcnt(1) lgkmcnt(0)
    s_barrier
    v_mfma_f32_32x32x16_bf16 v[80:95], v[20:23], v[16:19], v[80:95]
    ds_read_b128 v[48:51], v5 offset:20480
    ds_read_b128 v[52:55], v8 offset:20480
    v_mfma_f32_32x32x16_bf16 v[96:111], v[24:27], v[16:19], v[96:111]
    ds_read_b128 v[56:59], v8 offset:22528
    ds_read_b128 v[60:63], v8 offset:24576
    v_mfma_f32_32x32x16_bf16 v[112:127], v[28:31], v[16:19], v[112:127]
    ds_read_b128 v[64:67], v5 offset:21504
    ds_read_b128 v[68:71], v8 offset:21504
    v_mfma_f32_32x32x16_bf16 v[80:95], v[36:39], v[32:35], v[80:95]
    ds_read_b128 v[72:75], v8 offset:23552
    ds_read_b128 v[76:79], v8 offset:25600
    v_mfma_f32_32x32x16_bf16 v[96:111], v[40:43], v[32:35], v[96:111]
    v_mfma_f32_32x32x16_bf16 v[112:127], v[44:47], v[32:35], v[112:127]
    s_waitcnt lgkmcnt(0)
    v_mfma_f32_32x32x16_bf16 v[80:95], v[52:55], v[48:51], v[80:95]
    v_mfma_f32_32x32x16_bf16 v[96:111], v[56:59], v[48:51], v[96:111]
    v_mfma_f32_32x32x16_bf16 v[112:127], v[60:63], v[48:51], v[112:127]
    v_mfma_f32_32x32x16_bf16 v[80:95], v[68:71], v[64:67], v[80:95]
    v_mfma_f32_32x32x16_bf16 v[96:111], v[72:75], v[64:67], v[96:111]
    v_mfma_f32_32x32x16_bf16 v[112:127], v[76:79], v[64:67], v[112:127]
    s_branch L_k4join_14
L_k4g1_13:
    s_add_u32 m0, s12, 0
    s_nop 0
    buffer_load_dwordx4 v3, s[16:19], s20 offen lds
    s_add_u32 s20, s20, 2048
    s_add_u32 m0, s12, 8192
    s_nop 0
    buffer_load_dwordx4 v3, s[16:19], s21 offen lds
    s_add_u32 s21, s21, 2048
    s_add_u32 m0, s12, 20480
    s_nop 0
    buffer_load_dwordx4 v3, s[16:19], s20 offen lds
    s_add_u32 s20, s20, 2048
    s_add_u32 m0, s12, 28672
    s_nop 0
    buffer_load_dwordx4 v3, s[16:19], s21 offen lds
    s_add_u32 s21, s21, 2048
    s_add_u32 m0, s12, 40960
    s_nop 0
    buffer_load_dwordx4 v3, s[16:19], s20 offen lds
    s_add_u32 s20, s20, 2048
    s_add_u32 m0, s12, 49152
    s_nop 0
    buffer_load_dwordx4 v3, s[16:19], s21 offen lds
    s_add_u32 s21, s21, 2048
    s_waitcnt vmcnt(4)
    s_barrier
    ds_read_b128 v[16:19], v5 offset:0
    ds_read_b128 v[20:23], v8 offset:0
    ds_read_b128 v[24:27], v8 offset:2048
    ds_read_b128 v[28:31], v8 offset:4096
    ds_read_b128 v[32:35], v5 offset:1024
    ds_read_b128 v[36:39], v8 offset:1024
    ds_read_b128 v[40:43], v8 offset:3072
    ds_read_b128 v[44:47], v8 offset:5120
    s_add_u32 m0, s12, 61440
    s_nop 0
    buffer_load_dwordx4 v3, s[16:19], s20 offen lds
    s_add_u32 s20, s20, 2048
    s_add_u32 m0, s12, 69632
    s_nop 0
    buffer_load_dwordx4 v3, s[16:19], s21 offen lds
    s_add_u32 s21, s21, 2048
    s_add_u32 m0, s12, 81920
    s_nop 0
    buffer_load_dwordx4 v3, s[16:19], s20 offen lds
    s_add_u32 s20, s20, 2048
    s_add_u32 m0, s12, 90112
    s_nop 0
    buffer_load_dwordx4 v3, s[16:19], s21 offen lds
    s_add_u32 s21, s21, 2048
    s_waitcnt vmcnt(6) lgkmcnt(0)
    s_barrier
    v_mfma_f32_32x32x16_bf16 v[80:95], v[20:23], v[16:19], 0
    ds_read_b128 v[48:51], v5 offset:20480
    ds_read_b128 v[52:55], v8 offset:20480
    v_mfma_f32_32x32x16_bf16 v[96:111], v[24:27], v[16:19], 0
    ds_read_b128 v[56:59], v8 offset:22528
    ds_read_b128 v[60:63], v8 offset:24576
    v_mfma_f32_32x32x16_bf16 v[112:127], v[28:31], v[16:19], 0
    ds_read_b128 v[64:67], v5 offset:21504
    ds_read_b128 v[68:71], v8 offset:21504
    v_mfma_f32_32x32x16_bf16 v[80:95], v[36:39], v[32:35], v[80:95]
    ds_read_b128 v[72:75], v8 offset:23552
    ds_read_b128 v[76:79], v8 offset:25600
    s_add_u32 m0, s12, 102400
    s_nop 0
    buffer_load_dwordx4 v3, s[16:19], s20 offen lds
    s_add_u32 s20, s20, 2048
    v_mfma_f32_32x32x16_bf16 v[96:111], v[40:43], v[32:35], v[96:111]
    s_add_u32 m0, s12, 110592
    s_nop 0
    buffer_load_dwordx4 v3, s[16:19], s21 offen lds
    s_add_u32 s21, s21, 2048
    v_mfma_f32_32x32x16_bf16 v[112:127], v[44:47], v[32:35], v[112:127]
    s_waitcnt vmcnt(6) lgkmcnt(0)
    s_barrier
    v_mfma_f32_32x32x16_bf16 v[80:95], v[52:55], v[48:51], v[80:95]
    ds_read_b128 v[16:19], v5 offset:40960
    ds_read_b128 v[20:23], v8 offset:40960
    v_mfma_f32_32x32x16_bf16 v[96:111], v[56:59], v[48:51], v[96:111]
    ds_read_b128 v[24:27], v8 offset:43008
    ds_read_b128 v[28:31], v8 offset:45056
    v_mfma_f32_32x32x16_bf16 v[112:127], v[60:63], v[48:51], v[112:127]
    ds_read_b128 v[32:35], v5 offset:41984
    ds_read_b128 v[36:39], v8 offset:41984
    v_mfma_f32_32x32x16_bf16 v[80:95], v[68:71], v[64:67], v[80:95]
    ds_read_b128 v[40:43], v8 offset:44032
    ds_read_b128 v[44:47], v8 offset:46080
    s_add_u32 m0, s12, 0
    s_nop 0
    buffer_load_dwordx4 v3, s[16:19], s20 offen lds
    s_add_u32 s20, s20, 2048
    v_mfma_f32_32x32x16_bf16 v[96:111], v[72:75], v[64:67], v[96:111]
    s_add_u32 m0, s12, 8192
    s_nop 0
    buffer_load_dwordx4 v3, s[16:19], s21 offen lds
    s_add_u32 s21, s21, 2048
    v_mfma_f32_32x32x16_bf16 v[112:127], v[76:79], v[64:67], v[112:127]
    s_waitcnt vmcnt(6) lgkmcnt(0)
    s_barrier
    v_mfma_f32_32x32x16_bf16 v[80:95], v[20:23], v[16:19], v[80:95]
    ds_read_b128 v[48:51], v6 offset:0
    ds_read_b128 v[52:55], v9 offset:0
    v_mfma_f32_32x32x16_bf16 v[96:111], v[24:27], v[16:19], v[96:111]
    ds_read_b128 v[56:59], v9 offset:2048
    ds_read_b128 v[60:63], v9 offset:4096
    v_mfma_f32_32x32x16_bf16 v[112:127], v[28:31], v[16:19], v[112:127]
    ds_read_b128 v[64:67], v6 offset:1024
    ds_read_b128 v[68:71], v9 offset:1024
    v_mfma_f32_32x32x16_bf16 v[80:95], v[36:39], v[32:35], v[80:95]
    ds_read_b128 v[72:75], v9 offset:3072
    ds_read_b128 v[76:79], v9 offset:5120
    s_add_u32 m0, s12, 20480
    s_nop 0
    buffer_load_dwordx4 v3, s[16:19], s20 offen lds
    s_add_u32 s20, s20, 2048
    v_mfma_f32_32x32x16_bf16 v[96:111], v[40:43], v[32:35], v[96:111]
    s_add_u32 m0, s12, 28672
    s_nop 0
    buffer_load_dwordx4 v3, s[16:19], s21 offen lds
    s_add_u32 s21, s21, 2048
    v_mfma_f32_32x32x16_bf16 v[112:127], v[44:47], v[32:35], v[112:127]
    s_waitcnt vmcnt(6) lgkmcnt(0)
    s_barrier
    v_mfma_f32_32x32x16_bf16 v[80:95], v[52:55], v[48:51], v[80:95]
    ds_read_b128 v[16:19], v6 offset:20480
    ds_read_b128 v[20:23], v9 offset:20480
    v_mfma_f32_32x32x16_bf16 v[96:111], v[56:59], v[48:51], v[96:111]
    ds_read_b128 v[24:27], v9 offset:22528
    ds_read_b128 v[28:31], v9 offset:24576
    v_mfma_f32_32x32x16_bf16 v[112:127], v[60:63], v[48:51], v[112:127]
    ds_read_b128 v[32:35], v6 offset:21504
    ds_read_b128 v[36:39], v9 offset:21504
    v_mfma_f32_32x32x16_bf16 v[80:95], v[68:71], v[64:67], v[80:95]
    ds_read_b128 v[40:43], v9 offset:23552
    ds_read_b128 v[44:47], v9 offset:25600
    s_add_u32 m0, s12, 40960
    s_nop 0
    buffer_load_dwordx4 v3, s[16:19], s20 offen lds
    s_add_u32 s20, s20, 2048
    v_mfma_f32_32x32x16_bf16 v[96:111], v[72:75], v[64:67], v[96:111]
    s_add_u32 m0, s12, 49152
    s_nop 0
    buffer_load_dwordx4 v3, s[16:19], s21 offen lds
    s_add_u32 s21, s21, 2048
    v_mfma_f32_32x32x16_bf16 v[112:127], v[76:79], v[64:67], v[112:127]
    s_waitcnt vmcnt(6) lgkmcnt(0)
    s_barrier
    v_mfma_f32_32x32x16_bf16 v[80:95], v[20:23], v[16:19], v[80:95]
    ds_read_b128 v[48:51], v6 offset:40960
    ds_read_b128 v[52:55], v9 offset:40960
    v_mfma_f32_32x32x16_bf16 v[96:111], v[24:27], v[16:19], v[96:111]
    ds_read_b128 v[56:59], v9 offset:43008
    ds_read_b128 v[60:63], v9 offset:45056
    v_mfma_f32_32x32x16_bf16 v[112:127], v[28:31], v[16:19], v[112:127]
    ds_read_b128 v[64:67], v6 offset:41984
    ds_read_b128 v[68:71], v9 offset:41984
    v_mfma_f32_32x32x16_bf16 v[80:95], v[36:39], v[32:35], v[80:95]
    ds_read_b128 v[72:75], v9 offset:44032
    ds_read_b128 v[76:79], v9 offset:46080
    s_add_u32 m0, s12, 61440
    s_nop 0
    buffer_load_dwordx4 v3, s[16:19], s20 offen lds
    s_add_u32 s20, s20, 2048
    v_mfma_f32_32x32x16_bf16 v[96:111], v[40:43], v[32:35], v[96:111]
    s_add_u32 m0, s12, 69632
    s_nop 0
    buffer_load_dwordx4 v3, s[16:19], s21 offen lds
    s_add_u32 s21, s21, 2048
    v_mfma_f32_32x32x16_bf16 v[112:127], v[44:47], v[32:35], v[112:127]
    s_waitcnt vmcnt(6) lgkmcnt(0)
    s_barrier
    v_mfma_f32_32x32x16_bf16 v[80:95], v[52:55], v[48:51], v[80:95]
    ds_read_b128 v[16:19], v5 offset:0
    ds_read_b128 v[20:23], v8 offset:0
    v_mfma_f32_32x32x16_bf16 v[96:111], v[56:59], v[48:51], v[96:111]
    ds_read_b128 v[24:27], v8 offset:2048
    ds_read_b128 v[28:31], v8 offset:4096
    v_mfma_f32_32x32x16_bf16 v[112:127], v[60:63], v[48:51], v[112:127]
    ds_read_b128 v[32:35], v5 offset:1024
    ds_read_b128 v[36:39], v8 offset:1024
    v_mfma_f32_32x32x16_bf16 v[80:95], v[68:71], v[64:67], v[80:95]
    ds_read_b128 v[40:43], v8 offset:3072
    ds_read_b128 v[44:47], v8 offset:5120
    s_add_u32 m0, s12, 81920
    s_nop 0
    buffer_load_dwordx4 v3, s[16:19], s20 offen lds
    s_add_u32 s20, s20, 2048
    v_mfma_f32_32x32x16_bf16 v[96:111], v[72:75], v[64:67], v[96:111]
    s_add_u32 m0, s12, 90112
    s_nop 0
    buffer_load_dwordx4 v3, s[16:19], s21 offen lds
    s_add_u32 s21, s21, 2048
    v_mfma_f32_32x32x16_bf16 v[112:127], v[76:79], v[64:67], v[112:127]
    s_waitcnt vmcnt(6) lgkmcnt(0)
    s_barrier
    v_mfma_f32_32x32x16_bf16 v[80:95], v[20:23], v[16:19], v[80:95]
    ds_read_b128 v[48:51], v5 offset:20480
    ds_read_b128 v[52:55], v8 offset:20480
    v_mfma_f32_32x32x16_bf16 v[96:111], v[24:27], v[16:19], v[96:111]
    ds_read_b128 v[56:59], v8 offset:22528
    ds_read_b128 v[60:63], v8 offset:24576
    v_mfma_f32_32x32x16_bf16 v[112:127], v[28:31], v[16:19], v[112:127]
    ds_read_b128 v[64:67], v5 offset:21504
    ds_read_b128 v[68:71], v8 offset:21504
    v_mfma_f32_32x32x16_bf16 v[80:95], v[36:39], v[32:35], v[80:95]
    ds_read_b128 v[72:75], v8 offset:23552
    ds_read_b128 v[76:79], v8 offset:25600
    s_add_u32 m0, s12, 102400
    s_nop 0
    buffer_load_dwordx4 v3, s[16:19], s20 offen lds
    s_add_u32 s20, s20, 2048
    v_mfma_f32_32x32x16_bf16 v[96:111], v[40:43], v[32:35], v[96:111]
    s_add_u32 m0, s12, 110592
    s_nop 0
    buffer_load_dwordx4 v3, s[16:19], s21 offen lds
    s_add_u32 s21, s21, 2048
    v_mfma_f32_32x32x16_bf16 v[112:127], v[44:47], v[32:35], v[112:127]
    s_waitcnt vmcnt(6) lgkmcnt(0)
    s_barrier
    v_mfma_f32_32x32x16_bf16 v[80:95], v[52:55], v[48:51], v[80:95]
    ds_read_b128 v[16:19], v5 offset:40960
    ds_read_b128 v[20:23], v8 offset:40960
    v_mfma_f32_32x32x16_bf16 v[96:111], v[56:59], v[48:51], v[96:111]
    ds_read_b128 v[24:27], v8 offset:43008
    ds_read_b128 v[28:31], v8 offset:45056
    v_mfma_f32_32x32x16_bf16 v[112:127], v[60:63], v[48:51], v[112:127]
    ds_read_b128 v[32:35], v5 offset:41984
    ds_read_b128 v[36:39], v8 offset:41984
    v_mfma_f32_32x32x16_bf16 v[80:95], v[68:71], v[64:67], v[80:95]
    ds_read_b128 v[40:43], v8 offset:44032
    ds_read_b128 v[44:47], v8 offset:46080
    s_add_u32 m0, s12, 0
    s_nop 0
    buffer_load_dwordx4 v3, s[16:19], s20 offen lds
    s_add_u32 s20, s20, 2048
    v_mfma_f32_32x32x16_bf16 v[96:111], v[72:75], v[64:67], v[96:111]
    s_add_u32 m0, s12, 8192
    s_nop 0
    buffer_load_dwordx4 v3, s[16:19], s21 offen lds
    s_add_u32 s21, s21, 2048
    v_mfma_f32_32x32x16_bf16 v[112:127], v[76:79], v[64:67], v[112:127]
    s_waitcnt vmcnt(6) lgkmcnt(0)
    s_barrier
    v_mfma_f32_32x32x16_bf16 v[80:95], v[20:23], v[16:19], v[80:95]
    ds_read_b128 v[48:51], v6 offset:0
    ds_read_b128 v[52:55], v9 offset:0
    v_mfma_f32_32x32x16_bf16 v[96:111], v[24:27], v[16:19], v[96:111]
    ds_read_b128 v[56:59], v9 offset:2048
    ds_read_b128 v[60:63], v9 offset:4096
    v_mfma_f32_32x32x16_bf16 v[112:127], v[28:31], v[16:19], v[112:127]
    ds_read_b128 v[64:67], v6 offset:1024
    ds_read_b128 v[68:71], v9 offset:1024
    v_mfma_f32_32x32x16_bf16 v[80:95], v[36:39], v[32:35], v[80:95]
    ds_read_b128 v[72:75], v9 offset:3072
    ds_read_b128 v[76:79], v9 offset:5120
    s_add_u32 m0, s12, 20480
    s_nop 0
    buffer_load_dwordx4 v3, s[16:19], s20 offen lds
    s_add_u32 s20, s20, 2048
    v_mfma_f32_32x32x16_bf16 v[96:111], v[40:43], v[32:35], v[96:111]
    s_add_u32 m0, s12, 28672
    s_nop 0
    buffer_load_dwordx4 v3, s[16:19], s21 offen lds
    s_add_u32 s21, s21, 2048
    v_mfma_f32_32x32x16_bf16 v[112:127], v[44:47], v[32:35], v[112:127]
    s_waitcnt vmcnt(6) lgkmcnt(0)
    s_barrier
    v_mfma_f32_32x32x16_bf16 v[80:95], v[52:55], v[48:51], v[80:95]
    ds_read_b128 v[16:19], v6 offset:20480
    ds_read_b128 v[20:23], v9 offset:20480
    v_mfma_f32_32x32x16_bf16 v[96:111], v[56:59], v[48:51], v[96:111]
    ds_read_b128 v[24:27], v9 offset:22528
    ds_read_b128 v[28:31], v9 offset:24576
    v_mfma_f32_32x32x16_bf16 v[112:127], v[60:63], v[48:51], v[112:127]
    ds_read_b128 v[32:35], v6 offset:21504
    ds_read_b128 v[36:39], v9 offset:21504
    v_mfma_f32_32x32x16_bf16 v[80:95], v[68:71], v[64:67], v[80:95]
    ds_read_b128 v[40:43], v9 offset:23552
    ds_read_b128 v[44:47], v9 offset:25600
    s_add_u32 m0, s12, 40960
    s_nop 0
    buffer_load_dwordx4 v3, s[16:19], s20 offen lds
    s_add_u32 s20, s20, 2048
    v_mfma_f32_32x32x16_bf16 v[96:111], v[72:75], v[64:67], v[96:111]
    s_add_u32 m0, s12, 49152
    s_nop 0
    buffer_load_dwordx4 v3, s[16:19], s21 offen lds
    s_add_u32 s21, s21, 2048
    v_mfma_f32_32x32x16_bf16 v[112:127], v[76:79], v[64:67], v[112:127]
    s_waitcnt vmcnt(6) lgkmcnt(0)
    s_barrier
    v_mfma_f32_32x32x16_bf16 v[80:95], v[20:23], v[16:19], v[80:95]
    ds_read_b128 v[48:51], v6 offset:40960
    ds_read_b128 v[52:55], v9 offset:40960
    v_mfma_f32_32x32x16_bf16 v[96:111], v[24:27], v[16:19], v[96:111]
    ds_read_b128 v[56:59], v9 offset:43008
    ds_read_b128 v[60:63], v9 offset:45056
    v_mfma_f32_32x32x16_bf16 v[112:127], v[28:31], v[16:19], v[112:127]
    ds_read_b128 v[64:67], v6 offset:41984
    ds_read_b128 v[68:71], v9 offset:41984
    v_mfma_f32_32x32x16_bf16 v[80:95], v[36:39], v[32:35], v[80:95]
    ds_read_b128 v[72:75], v9 offset:44032
    ds_read_b128 v[76:79], v9 offset:46080
    s_add_u32 m0, s12, 61440
    s_nop 0
    buffer_load_dwordx4 v3, s[16:19], s20 offen lds
    s_add_u32 s20, s20, 2048
    v_mfma_f32_32x32x16_bf16 v[96:111], v[40:43], v[32:35], v[96:111]
    s_add_u32 m0, s12, 69632
    s_nop 0
    buffer_load_dwordx4 v3, s[16:19], s21 offen lds
    s_add_u32 s21, s21, 2048
    v_mfma_f32_32x32x16_bf16 v[112:127], v[44:47], v[32:35], v[112:127]
    s_waitcnt vmcnt(6) lgkmcnt(0)
    s_barrier
    v_mfma_f32_32x32x16_bf16 v[80:95], v[52:55], v[48:51], v[80:95]
    ds_read_b128 v[16:19], v5 offset:0
    ds_read_b128 v[20:23], v8 offset:0
    v_mfma_f32_32x32x16_bf16 v[96:111], v[56:59], v[48:51], v[96:111]
    ds_read_b128 v[24:27], v8 offset:2048
    ds_read_b128 v[28:31], v8 offset:4096
    v_mfma_f32_32x32x16_bf16 v[112:127], v[60:63], v[48:51], v[112:127]
    ds_read_b128 v[32:35], v5 offset:1024
    ds_read_b128 v[36:39], v8 offset:1024
    v_mfma_f32_32x32x16_bf16 v[80:95], v[68:71], v[64:67], v[80:95]
    ds_read_b128 v[40:43], v8 offset:3072
    ds_read_b128 v[44:47], v8 offset:5120
    s_add_u32 m0, s12, 81920
    s_nop 0
    buffer_load_dwordx4 v3, s[16:19], s20 offen lds
    s_add_u32 s20, s20, 2048
    v_mfma_f32_32x32x16_bf16 v[96:111], v[72:75], v[64:67], v[96:111]
    s_add_u32 m0, s12, 90112
    s_nop 0
    buffer_load_dwordx4 v3, s[16:19], s21 offen lds
    s_add_u32 s21, s21, 2048
    v_mfma_f32_32x32x16_bf16 v[112:127], v[76:79], v[64:67], v[112:127]
    s_waitcnt vmcnt(6) lgkmcnt(0)
    s_barrier
    v_mfma_f32_32x32x16_bf16 v[80:95], v[20:23], v[16:19], v[80:95]
    ds_read_b128 v[48:51], v5 offset:20480
    ds_read_b128 v[52:55], v8 offset:20480
    v_mfma_f32_32x32x16_bf16 v[96:111], v[24:27], v[16:19], v[96:111]
    ds_read_b128 v[56:59], v8 offset:22528
    ds_read_b128 v[60:63], v8 offset:24576
    v_mfma_f32_32x32x16_bf16 v[112:127], v[28:31], v[16:19], v[112:127]
    ds_read_b128 v[64:67], v5 offset:21504
    ds_read_b128 v[68:71], v8 offset:21504
    v_mfma_f32_32x32x16_bf16 v[80:95], v[36:39], v[32:35], v[80:95]
    ds_read_b128 v[72:75], v8 offset:23552
    ds_read_b128 v[76:79], v8 offset:25600
    s_add_u32 m0, s12, 102400
    s_nop 0
    buffer_load_dwordx4 v3, s[16:19], s20 offen lds
    s_add_u32 s20, s20, 2048
    v_mfma_f32_32x32x16_bf16 v[96:111], v[40:43], v[32:35], v[96:111]
    s_add_u32 m0, s12, 110592
    s_nop 0
    buffer_load_dwordx4 v3, s[16:19], s21 offen lds
    s_add_u32 s21, s21, 2048
    v_mfma_f32_32x32x16_bf16 v[112:127], v[44:47], v[32:35], v[112:127]
    s_waitcnt vmcnt(6) lgkmcnt(0)
    s_barrier
    v_mfma_f32_32x32x16_bf16 v[80:95], v[52:55], v[48:51], v[80:95]
    ds_read_b128 v[16:19], v5 offset:40960
    ds_read_b128 v[20:23], v8 offset:40960
    v_mfma_f32_32x32x16_bf16 v[96:111], v[56:59], v[48:51], v[96:111]
    ds_read_b128 v[24:27], v8 offset:43008
    ds_read_b128 v[28:31], v8 offset:45056
    v_mfma_f32_32x32x16_bf16 v[112:127], v[60:63], v[48:51], v[112:127]
    ds_read_b128 v[32:35], v5 offset:41984
    ds_read_b128 v[36:39], v8 offset:41984
    v_mfma_f32_32x32x16_bf16 v[80:95], v[68:71], v[64:67], v[80:95]
    ds_read_b128 v[40:43], v8 offset:44032
    ds_read_b128 v[44:47], v8 offset:46080
    s_add_u32 m0, s12, 0
    s_nop 0
    buffer_load_dwordx4 v3, s[16:19], s20 offen lds
    s_add_u32 s20, s20, 2048
    v_mfma_f32_32x32x16_bf16 v[96:111], v[72:75], v[64:67], v[96:111]
    s_add_u32 m0, s12, 8192
    s_nop 0
    buffer_load_dwordx4 v3, s[16:19], s21 offen lds
    s_add_u32 s21, s21, 2048
    v_mfma_f32_32x32x16_bf16 v[112:127], v[76:79], v[64:67], v[112:127]
    s_waitcnt vmcnt(6) lgkmcnt(0)
    s_barrier
    v_mfma_f32_32x32x16_bf16 v[80:95], v[20:23], v[16:19], v[80:95]
    ds_read_b128 v[48:51], v6 offset:0
    ds_read_b128 v[52:55], v9 offset:0
    v_mfma_f32_32x32x16_bf16 v[96:111], v[24:27], v[16:19], v[96:111]
    ds_read_b128 v[56:59], v9 offset:2048
    ds_read_b128 v[60:63], v9 offset:4096
    v_mfma_f32_32x32x16_bf16 v[112:127], v[28:31], v[16:19], v[112:127]
    ds_read_b128 v[64:67], v6 offset:1024
    ds_read_b128 v[68:71], v9 offset:1024
    v_mfma_f32_32x32x16_bf16 v[80:95], v[36:39], v[32:35], v[80:95]
    ds_read_b128 v[72:75], v9 offset:3072
    ds_read_b128 v[76:79], v9 offset:5120
    s_add_u32 m0, s12, 20480
    s_nop 0
    buffer_load_dwordx4 v3, s[16:19], s20 offen lds
    s_add_u32 s20, s20, 2048
    v_mfma_f32_32x32x16_bf16 v[96:111], v[40:43], v[32:35], v[96:111]
    s_add_u32 m0, s12, 28672
    s_nop 0
    buffer_load_dwordx4 v3, s[16:19], s21 offen lds
    s_add_u32 s21, s21, 2048
    v_mfma_f32_32x32x16_bf16 v[112:127], v[44:47], v[32:35], v[112:127]
    s_waitcnt vmcnt(6) lgkmcnt(0)
    s_barrier
    v_mfma_f32_32x32x16_bf16 v[80:95], v[52:55], v[48:51], v[80:95]
    ds_read_b128 v[16:19], v6 offset:20480
    ds_read_b128 v[20:23], v9 offset:20480
    v_mfma_f32_32x32x16_bf16 v[96:111], v[56:59], v[48:51], v[96:111]
    ds_read_b128 v[24:27], v9 offset:22528
    ds_read_b128 v[28:31], v9 offset:24576
    v_mfma_f32_32x32x16_bf16 v[112:127], v[60:63], v[48:51], v[112:127]
    ds_read_b128 v[32:35], v6 offset:21504
    ds_read_b128 v[36:39], v9 offset:21504
    v_mfma_f32_32x32x16_bf16 v[80:95], v[68:71], v[64:67], v[80:95]
    ds_read_b128 v[40:43], v9 offset:23552
    ds_read_b128 v[44:47], v9 offset:25600
    v_mfma_f32_32x32x16_bf16 v[96:111], v[72:75], v[64:67], v[96:111]
    buffer_load_dword v128, v14, s[16:19], s31 offen
    v_mfma_f32_32x32x16_bf16 v[112:127], v[76:79], v[64:67], v[112:127]
    s_waitcnt vmcnt(5) lgkmcnt(0)
    s_barrier
    v_mfma_f32_32x32x16_bf16 v[80:95], v[20:23], v[16:19], v[80:95]
    ds_read_b128 v[48:51], v6 offset:40960
    ds_read_b128 v[52:55], v9 offset:40960
    v_mfma_f32_32x32x16_bf16 v[96:111], v[24:27], v[16:19], v[96:111]
    ds_read_b128 v[56:59], v9 offset:43008
    ds_read_b128 v[60:63], v9 offset:45056
    v_mfma_f32_32x32x16_bf16 v[112:127], v[28:31], v[16:19], v[112:127]
    ds_read_b128 v[64:67], v6 offset:41984
    ds_read_b128 v[68:71], v9 offset:41984
    v_mfma_f32_32x32x16_bf16 v[80:95], v[36:39], v[32:35], v[80:95]
    ds_read_b128 v[72:75], v9 offset:44032
    ds_read_b128 v[76:79], v9 offset:46080
    v_mfma_f32_32x32x16_bf16 v[96:111], v[40:43], v[32:35], v[96:111]
    v_mfma_f32_32x32x16_bf16 v[112:127], v[44:47], v[32:35], v[112:127]
    s_waitcnt vmcnt(3) lgkmcnt(0)
    s_barrier
    v_mfma_f32_32x32x16_bf16 v[80:95], v[52:55], v[48:51], v[80:95]
    ds_read_b128 v[16:19], v5 offset:0
    ds_read_b128 v[20:23], v8 offset:0
    v_mfma_f32_32x32x16_bf16 v[96:111], v[56:59], v[48:51], v[96:111]
    ds_read_b128 v[24:27], v8 offset:2048
    ds_read_b128 v[28:31], v8 offset:4096
    v_mfma_f32_32x32x16_bf16 v[112:127], v[60:63], v[48:51], v[112:127]
    ds_read_b128 v[32:35], v5 offset:1024
    ds_read_b128 v[36:39], v8 offset:1024
    v_mfma_f32_32x32x16_bf16 v[80:95], v[68:71], v[64:67], v[80:95]
    ds_read_b128 v[40:43], v8 offset:3072
    ds_read_b128 v[44:47], v8 offset:5120
    v_mfma_f32_32x32x16_bf16 v[96:111], v[72:75], v[64:67], v[96:111]
    v_mfma_f32_32x32x16_bf16 v[112:127], v[76:79], v[64:67], v[112:127]
    s_waitcnt vmcnt(1) lgkmcnt(0)
    s_barrier
    v_mfma_f32_32x32x16_bf16 v[80:95], v[20:23], v[16:19], v[80:95]
    ds_read_b128 v[48:51], v5 offset:20480
    ds_read_b128 v[52:55], v8 offset:20480
    v_mfma_f32_32x32x16_bf16 v[96:111], v[24:27], v[16:19], v[96:111]
    ds_read_b128 v[56:59], v8 offset:22528
    ds_read_b128 v[60:63], v8 offset:24576
    v_mfma_f32_32x32x16_bf16 v[112:127], v[28:31], v[16:19], v[112:127]
    ds_read_b128 v[64:67], v5 offset:21504
    ds_read_b128 v[68:71], v8 offset:21504
    v_mfma_f32_32x32x16_bf16 v[80:95], v[36:39], v[32:35], v[80:95]
    ds_read_b128 v[72:75], v8 offset:23552
    ds_read_b128 v[76:79], v8 offset:25600
    v_mfma_f32_32x32x16_bf16 v[96:111], v[40:43], v[32:35], v[96:111]
    v_mfma_f32_32x32x16_bf16 v[112:127], v[44:47], v[32:35], v[112:127]
    s_waitcnt lgkmcnt(0)
    v_mfma_f32_32x32x16_bf16 v[80:95], v[52:55], v[48:51], v[80:95]
    v_mfma_f32_32x32x16_bf16 v[96:111], v[56:59], v[48:51], v[96:111]
    v_mfma_f32_32x32x16_bf16 v[112:127], v[60:63], v[48:51], v[112:127]
    v_mfma_f32_32x32x16_bf16 v[80:95], v[68:71], v[64:67], v[80:95]
    v_mfma_f32_32x32x16_bf16 v[96:111], v[72:75], v[64:67], v[96:111]
    v_mfma_f32_32x32x16_bf16 v[112:127], v[76:79], v[64:67], v[112:127]
L_k4join_14:
    v_bfe_u32 v12, v1, 4, 1
    v_mul_u32_u24 v12, 49152, v12
    v_and_b32 v13, 15, v1
    v_lshl_add_u32 v12, v13, 4, v12
    v_lshrrev_b32 v13, 5, v1
    v_lshl_add_u32 v12, v13, 8, v12
    s_lshl_b32 s13, s9, 2
    s_add_u32 s13, s13, s10
    s_mul_i32 s13, s13, 98304
    s_add_u32 s13, s13, 0x2000000
    s_mul_i32 s14, s8, 6
    s_mul_i32 s15, s11, 3
    s_add_u32 s14, s14, s15
    s_lshl_b32 s14, s14, 9
    s_add_u32 s13, s13, s14
    s_mov_b32 s40, 0xbdd2d3e8
    s_mov_b32 s41, 0xbdd2d3e8
    v_mov_b32 v40, 0xc0135761
    v_mov_b32 v41, 0xc0135761
    s_mov_b32 s44, 1.0
    s_mov_b32 s45, 1.0
    s_nop 7
    v_cvt_pk_bf16_f32 v17, v80, v81
    v_cvt_pk_bf16_f32 v19, v82, v83
    v_cvt_pk_bf16_f32 v21, v84, v85
    v_cvt_pk_bf16_f32 v23, v86, v87
    v_cvt_pk_bf16_f32 v25, v88, v89
    v_cvt_pk_bf16_f32 v27, v90, v91
    v_cvt_pk_bf16_f32 v29, v92, v93
    v_cvt_pk_bf16_f32 v31, v94, v95
    v_lshlrev_b32 v16, 16, v17
    v_and_b32 v17, 0xffff0000, v17
    v_lshlrev_b32 v18, 16, v19
    v_and_b32 v19, 0xffff0000, v19
    v_lshlrev_b32 v20, 16, v21
    v_and_b32 v21, 0xffff0000, v21
    v_lshlrev_b32 v22, 16, v23
    v_and_b32 v23, 0xffff0000, v23
    v_pk_mul_f32 v[32:33], v[16:17], v[16:17]
    v_pk_mul_f32 v[34:35], v[18:19], v[18:19]
    v_pk_mul_f32 v[36:37], v[20:21], v[20:21]
    v_pk_mul_f32 v[38:39], v[22:23], v[22:23]
    v_pk_fma_f32 v[32:33], v[32:33], s[40:41], v[40:41]
    v_pk_fma_f32 v[34:35], v[34:35], s[40:41], v[40:41]
    v_pk_fma_f32 v[36:37], v[36:37], s[40:41], v[40:41]
    v_pk_fma_f32 v[38:39], v[38:39], s[40:41], v[40:41]
    v_pk_mul_f32 v[32:33], v[32:33], v[16:17]
    v_pk_mul_f32 v[34:35], v[34:35], v[18:19]
    v_pk_mul_f32 v[36:37], v[36:37], v[20:21]
    v_pk_mul_f32 v[38:39], v[38:39], v[22:23]
    v_exp_f32 v32, v32
    v_exp_f32 v33, v33
    v_exp_f32 v34, v34
    v_exp_f32 v35, v35
    v_exp_f32 v36, v36
    v_exp_f32 v37, v37
    v_exp_f32 v38, v38
    v_exp_f32 v39, v39
    v_lshlrev_b32 v24, 16, v25
    v_and_b32 v25, 0xffff0000, v25
    v_lshlrev_b32 v26, 16, v27
    v_and_b32 v27, 0xffff0000, v27
    v_lshlrev_b32 v28, 16, v29
    v_and_b32 v29, 0xffff0000, v29
    v_lshlrev_b32 v30, 16, v31
    v_and_b32 v31, 0xffff0000, v31
    v_pk_add_f32 v[32:33], v[32:33], s[44:45]
    v_pk_add_f32 v[34:35], v[34:35], s[44:45]
    v_pk_add_f32 v[36:37], v[36:37], s[44:45]
    v_pk_add_f32 v[38:39], v[38:39], s[44:45]
    v_rcp_f32 v32, v32
    v_rcp_f32 v33, v33
    v_rcp_f32 v34, v34
    v_rcp_f32 v35, v35
    v_rcp_f32 v36, v36
    v_rcp_f32 v37, v37
    v_rcp_f32 v38, v38
    v_rcp_f32 v39, v39
    s_nop 0
    v_pk_mul_f32 v[32:33], v[32:33], v[16:17]
    v_pk_mul_f32 v[34:35], v[34:35], v[18:19]
    v_pk_mul_f32 v[36:37], v[36:37], v[20:21]
    v_pk_mul_f32 v[38:39], v[38:39], v[22:23]
    v_cvt_pk_bf16_f32 v33, v32, v33
    v_cvt_pk_bf16_f32 v35, v34, v35
    v_cvt_pk_bf16_f32 v37, v36, v37
    v_cvt_pk_bf16_f32 v39, v38, v39
    v_lshlrev_b32 v32, 16, v33
    v_and_b32 v33, 0xffff0000, v33
    v_lshlrev_b32 v34, 16, v35
    v_and_b32 v35, 0xffff0000, v35
    v_lshlrev_b32 v36, 16, v37
    v_and_b32 v37, 0xffff0000, v37
    v_lshlrev_b32 v38, 16, v39
    v_and_b32 v39, 0xffff0000, v39
    v_pk_mul_f32 v[32:33], v[32:33], v[24:25]
    v_pk_mul_f32 v[34:35], v[34:35], v[26:27]
    v_pk_mul_f32 v[36:37], v[36:37], v[28:29]
    v_pk_mul_f32 v[38:39], v[38:39], v[30:31]
    v_cvt_pk_bf16_f32 v80, v32, v33
    v_cvt_pk_bf16_f32 v81, v34, v35
    v_cvt_pk_bf16_f32 v82, v36, v37
    v_cvt_pk_bf16_f32 v83, v38, v39
    s_nop 1
    v_permlane32_swap_b32 v80, v82
    v_permlane32_swap_b32 v81, v83
    buffer_store_dwordx4 v[80:83], v12, s[16:19], s13 offen offset:0 sc1
    v_cvt_pk_bf16_f32 v17, v96, v97
    v_cvt_pk_bf16_f32 v19, v98, v99
    v_cvt_pk_bf16_f32 v21, v100, v101
    v_cvt_pk_bf16_f32 v23, v102, v103
    v_cvt_pk_bf16_f32 v25, v104, v105
    v_cvt_pk_bf16_f32 v27, v106, v107
    v_cvt_pk_bf16_f32 v29, v108, v109
    v_cvt_pk_bf16_f32 v31, v110, v111
    v_lshlrev_b32 v16, 16, v17
    v_and_b32 v17, 0xffff0000, v17
    v_lshlrev_b32 v18, 16, v19
    v_and_b32 v19, 0xffff0000, v19
    v_lshlrev_b32 v20, 16, v21
    v_and_b32 v21, 0xffff0000, v21
    v_lshlrev_b32 v22, 16, v23
    v_and_b32 v23, 0xffff0000, v23
    v_pk_mul_f32 v[32:33], v[16:17], v[16:17]
    v_pk_mul_f32 v[34:35], v[18:19], v[18:19]
    v_pk_mul_f32 v[36:37], v[20:21], v[20:21]
    v_pk_mul_f32 v[38:39], v[22:23], v[22:23]
    v_pk_fma_f32 v[32:33], v[32:33], s[40:41], v[40:41]
    v_pk_fma_f32 v[34:35], v[34:35], s[40:41], v[40:41]
    v_pk_fma_f32 v[36:37], v[36:37], s[40:41], v[40:41]
    v_pk_fma_f32 v[38:39], v[38:39], s[40:41], v[40:41]
    v_pk_mul_f32 v[32:33], v[32:33], v[16:17]
    v_pk_mul_f32 v[34:35], v[34:35], v[18:19]
    v_pk_mul_f32 v[36:37], v[36:37], v[20:21]
    v_pk_mul_f32 v[38:39], v[38:39], v[22:23]
    v_exp_f32 v32, v32
    v_exp_f32 v33, v33
    v_exp_f32 v34, v34
    v_exp_f32 v35, v35
    v_exp_f32 v36, v36
    v_exp_f32 v37, v37
    v_exp_f32 v38, v38
    v_exp_f32 v39, v39
    v_lshlrev_b32 v24, 16, v25
    v_and_b32 v25, 0xffff0000, v25
    v_lshlrev_b32 v26, 16, v27
    v_and_b32 v27, 0xffff0000, v27
    v_lshlrev_b32 v28, 16, v29
    v_and_b32 v29, 0xffff0000, v29
    v_lshlrev_b32 v30, 16, v31
    v_and_b32 v31, 0xffff0000, v31
    v_pk_add_f32 v[32:33], v[32:33], s[44:45]
    v_pk_add_f32 v[34:35], v[34:35], s[44:45]
    v_pk_add_f32 v[36:37], v[36:37], s[44:45]
    v_pk_add_f32 v[38:39], v[38:39], s[44:45]
    v_rcp_f32 v32, v32
    v_rcp_f32 v33, v33
    v_rcp_f32 v34, v34
    v_rcp_f32 v35, v35
    v_rcp_f32 v36, v36
    v_rcp_f32 v37, v37
    v_rcp_f32 v38, v38
    v_rcp_f32 v39, v39
    s_nop 0
    v_pk_mul_f32 v[32:33], v[32:33], v[16:17]
    v_pk_mul_f32 v[34:35], v[34:35], v[18:19]
    v_pk_mul_f32 v[36:37], v[36:37], v[20:21]
    v_pk_mul_f32 v[38:39], v[38:39], v[22:23]
    v_cvt_pk_bf16_f32 v33, v32, v33
    v_cvt_pk_bf16_f32 v35, v34, v35
    v_cvt_pk_bf16_f32 v37, v36, v37
    v_cvt_pk_bf16_f32 v39, v38, v39
    v_lshlrev_b32 v32, 16, v33
    v_and_b32 v33, 0xffff0000, v33
    v_lshlrev_b32 v34, 16, v35
    v_and_b32 v35, 0xffff0000, v35
    v_lshlrev_b32 v36, 16, v37
    v_and_b32 v37, 0xffff0000, v37
    v_lshlrev_b32 v38, 16, v39
    v_and_b32 v39, 0xffff0000, v39
    v_pk_mul_f32 v[32:33], v[32:33], v[24:25]
    v_pk_mul_f32 v[34:35], v[34:35], v[26:27]
    v_pk_mul_f32 v[36:37], v[36:37], v[28:29]
    v_pk_mul_f32 v[38:39], v[38:39], v[30:31]
    v_cvt_pk_bf16_f32 v96, v32, v33
    v_cvt_pk_bf16_f32 v97, v34, v35
    v_cvt_pk_bf16_f32 v98, v36, v37
    v_cvt_pk_bf16_f32 v99, v38, v39
    s_nop 1
    v_permlane32_swap_b32 v96, v98
    v_permlane32_swap_b32 v97, v99
    buffer_store_dwordx4 v[96:99], v12, s[16:19], s13 offen offset:512 sc1
    v_cvt_pk_bf16_f32 v17, v112, v113
    v_cvt_pk_bf16_f32 v19, v114, v115
    v_cvt_pk_bf16_f32 v21, v116, v117
    v_cvt_pk_bf16_f32 v23, v118, v119
    v_cvt_pk_bf16_f32 v25, v120, v121
    v_cvt_pk_bf16_f32 v27, v122, v123
    v_cvt_pk_bf16_f32 v29, v124, v125
    v_cvt_pk_bf16_f32 v31, v126, v127
    v_lshlrev_b32 v16, 16, v17
    v_and_b32 v17, 0xffff0000, v17
    v_lshlrev_b32 v18, 16, v19
    v_and_b32 v19, 0xffff0000, v19
    v_lshlrev_b32 v20, 16, v21
    v_and_b32 v21, 0xffff0000, v21
    v_lshlrev_b32 v22, 16, v23
    v_and_b32 v23, 0xffff0000, v23
    v_pk_mul_f32 v[32:33], v[16:17], v[16:17]
    v_pk_mul_f32 v[34:35], v[18:19], v[18:19]
    v_pk_mul_f32 v[36:37], v[20:21], v[20:21]
    v_pk_mul_f32 v[38:39], v[22:23], v[22:23]
    v_pk_fma_f32 v[32:33], v[32:33], s[40:41], v[40:41]
    v_pk_fma_f32 v[34:35], v[34:35], s[40:41], v[40:41]
    v_pk_fma_f32 v[36:37], v[36:37], s[40:41], v[40:41]
    v_pk_fma_f32 v[38:39], v[38:39], s[40:41], v[40:41]
    v_pk_mul_f32 v[32:33], v[32:33], v[16:17]
    v_pk_mul_f32 v[34:35], v[34:35], v[18:19]
    v_pk_mul_f32 v[36:37], v[36:37], v[20:21]
    v_pk_mul_f32 v[38:39], v[38:39], v[22:23]
    v_exp_f32 v32, v32
    v_exp_f32 v33, v33
    v_exp_f32 v34, v34
    v_exp_f32 v35, v35
    v_exp_f32 v36, v36
    v_exp_f32 v37, v37
    v_exp_f32 v38, v38
    v_exp_f32 v39, v39
    v_lshlrev_b32 v24, 16, v25
    v_and_b32 v25, 0xffff0000, v25
    v_lshlrev_b32 v26, 16, v27
    v_and_b32 v27, 0xffff0000, v27
    v_lshlrev_b32 v28, 16, v29
    v_and_b32 v29, 0xffff0000, v29
    v_lshlrev_b32 v30, 16, v31
    v_and_b32 v31, 0xffff0000, v31
    v_pk_add_f32 v[32:33], v[32:33], s[44:45]
    v_pk_add_f32 v[34:35], v[34:35], s[44:45]
    v_pk_add_f32 v[36:37], v[36:37], s[44:45]
    v_pk_add_f32 v[38:39], v[38:39], s[44:45]
    v_rcp_f32 v32, v32
    v_rcp_f32 v33, v33
    v_rcp_f32 v34, v34
    v_rcp_f32 v35, v35
    v_rcp_f32 v36, v36
    v_rcp_f32 v37, v37
    v_rcp_f32 v38, v38
    v_rcp_f32 v39, v39
    s_nop 0
    v_pk_mul_f32 v[32:33], v[32:33], v[16:17]
    v_pk_mul_f32 v[34:35], v[34:35], v[18:19]
    v_pk_mul_f32 v[36:37], v[36:37], v[20:21]
    v_pk_mul_f32 v[38:39], v[38:39], v[22:23]
    v_cvt_pk_bf16_f32 v33, v32, v33
    v_cvt_pk_bf16_f32 v35, v34, v35
    v_cvt_pk_bf16_f32 v37, v36, v37
    v_cvt_pk_bf16_f32 v39, v38, v39
    v_lshlrev_b32 v32, 16, v33
    v_and_b32 v33, 0xffff0000, v33
    v_lshlrev_b32 v34, 16, v35
    v_and_b32 v35, 0xffff0000, v35
    v_lshlrev_b32 v36, 16, v37
    v_and_b32 v37, 0xffff0000, v37
    v_lshlrev_b32 v38, 16, v39
    v_and_b32 v39, 0xffff0000, v39
    v_pk_mul_f32 v[32:33], v[32:33], v[24:25]
    v_pk_mul_f32 v[34:35], v[34:35], v[26:27]
    v_pk_mul_f32 v[36:37], v[36:37], v[28:29]
    v_pk_mul_f32 v[38:39], v[38:39], v[30:31]
    v_cvt_pk_bf16_f32 v112, v32, v33
    v_cvt_pk_bf16_f32 v113, v34, v35
    v_cvt_pk_bf16_f32 v114, v36, v37
    v_cvt_pk_bf16_f32 v115, v38, v39
    s_nop 1
    v_permlane32_swap_b32 v112, v114
    v_permlane32_swap_b32 v113, v115
    buffer_store_dwordx4 v[112:115], v12, s[16:19], s13 offen offset:1024 sc1
L_k4end_12:
    s_endpgm
.globl k5_kernel
.p2align 8
.type k5_kernel,@function
k5_kernel:
    s_cmp_ge_u32 s2, 256
    s_cbranch_scc1 L_k5end_15
    s_load_dwordx2 s[6:7], s[0:1], 72
    s_load_dwordx2 s[4:5], s[0:1], 56
    v_and_b32 v1, 63, v0
    v_lshrrev_b32 v2, 6, v0
    s_nop 0
    v_readfirstlane_b32 s3, v2
    s_and_b32 s13, s2, 7
    s_lshr_b32 s14, s2, 3
    s_and_b32 s8, s13, 1
    s_lshl_b32 s8, s8, 2
    s_and_b32 s15, s14, 3
    s_add_u32 s8, s8, s15
    s_lshr_b32 s9, s13, 1
    s_lshl_b32 s9, s9, 3
    s_lshr_b32 s15, s14, 2
    s_add_u32 s9, s9, s15
    v_lshlrev_b32 v3, 4, v1
    s_lshl_b32 s12, s3, 10
    s_mul_i32 s13, s9, 196608
    s_add_u32 s13, s13, s12
    s_add_u32 s13, s13, 0x2000000
    s_add_u32 s20, s13, 0
    s_add_u32 s21, s13, 49152
    s_add_u32 s22, s13, 98304
    s_add_u32 s23, s13, 147456
    s_mul_i32 s13, s8, 245760
    s_add_u32 s13, s13, s12
    s_add_u32 s13, s13, 0x1c00000
    s_add_u32 s24, s13, 0
    s_add_u32 s25, s13, 49152
    s_add_u32 s26, s13, 98304
    s_add_u32 s27, s13, 147456
    s_add_u32 s28, s13, 196608
    s_waitcnt lgkmcnt(0)
    s_mov_b32 s16, s6
    s_and_b32 s17, s7, 0xffff
    s_mov_b32 s18, 0x10000000
    s_mov_b32 s19, 0x00020000
    s_mov_b32 s32, s4
    s_and_b32 s33, s5, 0xffff
    s_mov_b32 s34, 0x280000
    s_mov_b32 s35, 0x00020000
    v_and_b32 v4, 15, v1
    v_mul_u32_u24 v4, 1280, v4
    v_lshrrev_b32 v5, 4, v1
    v_lshl_add_u32 v4, v5, 3, v4
    s_lshl_b32 s13, s9, 2
    s_add_u32 s13, s13, s3
    s_mul_i32 s13, s13, 20480
    s_mul_i32 s14, s8, 160
    s_add_u32 s13, s13, s14
    s_add_u32 s14, s13, 0x1000000
    buffer_load_dwordx2 v[6:7], v4, s[16:19], s14 offen offset:0
    buffer_load_dwordx2 v[8:9], v4, s[16:19], s14 offen offset:32
    buffer_load_dwordx2 v[10:11], v4, s[16:19], s14 offen offset:64
    buffer_load_dwordx2 v[12:13], v4, s[16:19], s14 offen offset:96
    buffer_load_dwordx2 v[14:15], v4, s[16:19], s14 offen offset:128
    buffer_load_dwordx4 v[16:19], v3, s[16:19], s20 offen
    s_add_u32 s20, s20, 4096
    buffer_load_dwordx4 v[20:23], v3, s[16:19], s21 offen
    s_add_u32 s21, s21, 4096
    buffer_load_dwordx4 v[24:27], v3, s[16:19], s22 offen
    s_add_u32 s22, s22, 4096
    buffer_load_dwordx4 v[28:31], v3, s[16:19], s23 offen
    s_add_u32 s23, s23, 4096
    buffer_load_dwordx4 v[32:35], v3, s[16:19], s24 offen
    s_add_u32 s24, s24, 4096
    buffer_load_dwordx4 v[36:39], v3, s[16:19], s25 offen
    s_add_u32 s25, s25, 4096
    buffer_load_dwordx4 v[40:43], v3, s[16:19], s26 offen
    s_add_u32 s26, s26, 4096
    buffer_load_dwordx4 v[44:47], v3, s[16:19], s27 offen
    s_add_u32 s27, s27, 4096
    buffer_load_dwordx4 v[48:51], v3, s[16:19], s28 offen
    s_add_u32 s28, s28, 4096
    buffer_load_dwordx4 v[52:55], v3, s[16:19], s20 offen
    s_add_u32 s20, s20, 4096
    buffer_load_dwordx4 v[56:59], v3, s[16:19], s21 offen
    s_add_u32 s21, s21, 4096
    buffer_load_dwordx4 v[60:63], v3, s[16:19], s22 offen
    s_add_u32 s22, s22, 4096
    buffer_load_dwordx4 v[64:67], v3, s[16:19], s23 offen
    s_add_u32 s23, s23, 4096
    buffer_load_dwordx4 v[68:71], v3, s[16:19], s24 offen
    s_add_u32 s24, s24, 4096
    buffer_load_dwordx4 v[72:75], v3, s[16:19], s25 offen
    s_add_u32 s25, s25, 4096
    buffer_load_dwordx4 v[76:79], v3, s[16:19], s26 offen
    s_add_u32 s26, s26, 4096
    buffer_load_dwordx4 v[80:83], v3, s[16:19], s27 offen
    s_add_u32 s27, s27, 4096
    buffer_load_dwordx4 v[84:87], v3, s[16:19], s28 offen
    s_add_u32 s28, s28, 4096
    buffer_load_dwordx4 v[88:91], v3, s[16:19], s20 offen
    s_add_u32 s20, s20, 4096
    buffer_load_dwordx4 v[92:95], v3, s[16:19], s21 offen
    s_add_u32 s21, s21, 4096
    buffer_load_dwordx4 v[96:99], v3, s[16:19], s22 offen
    s_add_u32 s22, s22, 4096
    buffer_load_dwordx4 v[100:103], v3, s[16:19], s23 offen
    s_add_u32 s23, s23, 4096
    buffer_load_dwordx4 v[104:107], v3, s[16:19], s24 offen
    s_add_u32 s24, s24, 4096
    buffer_load_dwordx4 v[108:111], v3, s[16:19], s25 offen
    s_add_u32 s25, s25, 4096
    buffer_load_dwordx4 v[112:115], v3, s[16:19], s26 offen
    s_add_u32 s26, s26, 4096
    buffer_load_dwordx4 v[116:119], v3, s[16:19], s27 offen
    s_add_u32 s27, s27, 4096
    buffer_load_dwordx4 v[120:123], v3, s[16:19], s28 offen
    s_add_u32 s28, s28, 4096
    buffer_load_dwordx4 v[124:127], v3, s[16:19], s20 offen
    s_add_u32 s20, s20, 4096
    buffer_load_dwordx4 v[128:131], v3, s[16:19], s21 offen
    s_add_u32 s21, s21, 4096
    buffer_load_dwordx4 v[132:135], v3, s[16:19], s22 offen
    s_add_u32 s22, s22, 4096
    buffer_load_dwordx4 v[136:139], v3, s[16:19], s23 offen
    s_add_u32 s23, s23, 4096
    buffer_load_dwordx4 v[140:143], v3, s[16:19], s24 offen
    s_add_u32 s24, s24, 4096
    buffer_load_dwordx4 v[144:147], v3, s[16:19], s25 offen
    s_add_u32 s25, s25, 4096
    buffer_load_dwordx4 v[148:151], v3, s[16:19], s26 offen
    s_add_u32 s26, s26, 4096
    buffer_load_dwordx4 v[152:155], v3, s[16:19], s27 offen
    s_add_u32 s27, s27, 4096
    buffer_load_dwordx4 v[156:159], v3, s[16:19], s28 offen
    s_add_u32 s28, s28, 4096
    s_waitcnt vmcnt(27)
    v_mfma_f32_16x16x32_bf16 a[0:3], v[32:35], v[16:19], 0
    v_mfma_f32_16x16x32_bf16 a[4:7], v[36:39], v[16:19], 0
    v_mfma_f32_16x16x32_bf16 a[8:11], v[40:43], v[16:19], 0
    v_mfma_f32_16x16x32_bf16 a[12:15], v[44:47], v[16:19], 0
    v_mfma_f32_16x16x32_bf16 a[16:19], v[48:51], v[16:19], 0
    v_mfma_f32_16x16x32_bf16 a[20:23], v[32:35], v[20:23], 0
    v_mfma_f32_16x16x32_bf16 a[24:27], v[36:39], v[20:23], 0
    v_mfma_f32_16x16x32_bf16 a[28:31], v[40:43], v[20:23], 0
    v_mfma_f32_16x16x32_bf16 a[32:35], v[44:47], v[20:23], 0
    v_mfma_f32_16x16x32_bf16 a[36:39], v[48:51], v[20:23], 0
    v_mfma_f32_16x16x32_bf16 a[40:43], v[32:35], v[24:27], 0
    v_mfma_f32_16x16x32_bf16 a[44:47], v[36:39], v[24:27], 0
    v_mfma_f32_16x16x32_bf16 a[48:51], v[40:43], v[24:27], 0
    v_mfma_f32_16x16x32_bf16 a[52:55], v[44:47], v[24:27], 0
    v_mfma_f32_16x16x32_bf16 a[56:59], v[48:51], v[24:27], 0
    v_mfma_f32_16x16x32_bf16 a[60:63], v[32:35], v[28:31], 0
    v_mfma_f32_16x16x32_bf16 a[64:67], v[36:39], v[28:31], 0
    v_mfma_f32_16x16x32_bf16 a[68:71], v[40:43], v[28:31], 0
    v_mfma_f32_16x16x32_bf16 a[72:75], v[44:47], v[28:31], 0
    v_mfma_f32_16x16x32_bf16 a[76:79], v[48:51], v[28:31], 0
    buffer_load_dwordx4 v[16:19], v3, s[16:19], s20 offen
    s_add_u32 s20, s20, 4096
    buffer_load_dwordx4 v[20:23], v3, s[16:19], s21 offen
    s_add_u32 s21, s21, 4096
    buffer_load_dwordx4 v[24:27], v3, s[16:19], s22 offen
    s_add_u32 s22, s22, 4096
    buffer_load_dwordx4 v[28:31], v3, s[16:19], s23 offen
    s_add_u32 s23, s23, 4096
    buffer_load_dwordx4 v[32:35], v3, s[16:19], s24 offen
    s_add_u32 s24, s24, 4096
    buffer_load_dwordx4 v[36:39], v3, s[16:19], s25 offen
    s_add_u32 s25, s25, 4096
    buffer_load_dwordx4 v[40:43], v3, s[16:19], s26 offen
    s_add_u32 s26, s26, 4096
    buffer_load_dwordx4 v[44:47], v3, s[16:19], s27 offen
    s_add_u32 s27, s27, 4096
    buffer_load_dwordx4 v[48:51], v3, s[16:19], s28 offen
    s_add_u32 s28, s28, 4096
    s_waitcnt vmcnt(27)
    v_mfma_f32_16x16x32_bf16 a[0:3], v[68:71], v[52:55], a[0:3]
    v_mfma_f32_16x16x32_bf16 a[4:7], v[72:75], v[52:55], a[4:7]
    v_mfma_f32_16x16x32_bf16 a[8:11], v[76:79], v[52:55], a[8:11]
    v_mfma_f32_16x16x32_bf16 a[12:15], v[80:83], v[52:55], a[12:15]
    v_mfma_f32_16x16x32_bf16 a[16:19], v[84:87], v[52:55], a[16:19]
    v_mfma_f32_16x16x32_bf16 a[20:23], v[68:71], v[56:59], a[20:23]
    v_mfma_f32_16x16x32_bf16 a[24:27], v[72:75], v[56:59], a[24:27]
    v_mfma_f32_16x16x32_bf16 a[28:31], v[76:79], v[56:59], a[28:31]
    v_mfma_f32_16x16x32_bf16 a[32:35], v[80:83], v[56:59], a[32:35]
    v_mfma_f32_16x16x32_bf16 a[36:39], v[84:87], v[56:59], a[36:39]
    v_mfma_f32_16x16x32_bf16 a[40:43], v[68:71], v[60:63], a[40:43]
    v_mfma_f32_16x16x32_bf16 a[44:47], v[72:75], v[60:63], a[44:47]
    v_mfma_f32_16x16x32_bf16 a[48:51], v[76:79], v[60:63], a[48:51]
    v_mfma_f32_16x16x32_bf16 a[52:55], v[80:83], v[60:63], a[52:55]
    v_mfma_f32_16x16x32_bf16 a[56:59], v[84:87], v[60:63], a[56:59]
    v_mfma_f32_16x16x32_bf16 a[60:63], v[68:71], v[64:67], a[60:63]
    v_mfma_f32_16x16x32_bf16 a[64:67], v[72:75], v[64:67], a[64:67]
    v_mfma_f32_16x16x32_bf16 a[68:71], v[76:79], v[64:67], a[68:71]
    v_mfma_f32_16x16x32_bf16 a[72:75], v[80:83], v[64:67], a[72:75]
    v_mfma_f32_16x16x32_bf16 a[76:79], v[84:87], v[64:67], a[76:79]
    buffer_load_dwordx4 v[52:55], v3, s[16:19], s20 offen
    s_add_u32 s20, s20, 4096
    buffer_load_dwordx4 v[56:59], v3, s[16:19], s21 offen
    s_add_u32 s21, s21, 4096
    buffer_load_dwordx4 v[60:63], v3, s[16:19], s22 offen
    s_add_u32 s22, s22, 4096
    buffer_load_dwordx4 v[64:67], v3, s[16:19], s23 offen
    s_add_u32 s23, s23, 4096
    buffer_load_dwordx4 v[68:71], v3, s[16:19], s24 offen
    s_add_u32 s24, s24, 4096
    buffer_load_dwordx4 v[72:75], v3, s[16:19], s25 offen
    s_add_u32 s25, s25, 4096
    buffer_load_dwordx4 v[76:79], v3, s[16:19], s26 offen
    s_add_u32 s26, s26, 4096
    buffer_load_dwordx4 v[80:83], v3, s[16:19], s27 offen
    s_add_u32 s27, s27, 4096
    buffer_load_dwordx4 v[84:87], v3, s[16:19], s28 offen
    s_add_u32 s28, s28, 4096
    s_waitcnt vmcnt(27)
    v_mfma_f32_16x16x32_bf16 a[0:3], v[104:107], v[88:91], a[0:3]
    v_mfma_f32_16x16x32_bf16 a[4:7], v[108:111], v[88:91], a[4:7]
    v_mfma_f32_16x16x32_bf16 a[8:11], v[112:115], v[88:91], a[8:11]
    v_mfma_f32_16x16x32_bf16 a[12:15], v[116:119], v[88:91], a[12:15]
    v_mfma_f32_16x16x32_bf16 a[16:19], v[120:123], v[88:91], a[16:19]
    v_mfma_f32_16x16x32_bf16 a[20:23], v[104:107], v[92:95], a[20:23]
    v_mfma_f32_16x16x32_bf16 a[24:27], v[108:111], v[92:95], a[24:27]
    v_mfma_f32_16x16x32_bf16 a[28:31], v[112:115], v[92:95], a[28:31]
    v_mfma_f32_16x16x32_bf16 a[32:35], v[116:119], v[92:95], a[32:35]
    v_mfma_f32_16x16x32_bf16 a[36:39], v[120:123], v[92:95], a[36:39]
    v_mfma_f32_16x16x32_bf16 a[40:43], v[104:107], v[96:99], a[40:43]
    v_mfma_f32_16x16x32_bf16 a[44:47], v[108:111], v[96:99], a[44:47]
    v_mfma_f32_16x16x32_bf16 a[48:51], v[112:115], v[96:99], a[48:51]
    v_mfma_f32_16x16x32_bf16 a[52:55], v[116:119], v[96:99], a[52:55]
    v_mfma_f32_16x16x32_bf16 a[56:59], v[120:123], v[96:99], a[56:59]
    v_mfma_f32_16x16x32_bf16 a[60:63], v[104:107], v[100:103], a[60:63]
    v_mfma_f32_16x16x32_bf16 a[64:67], v[108:111], v[100:103], a[64:67]
    v_mfma_f32_16x16x32_bf16 a[68:71], v[112:115], v[100:103], a[68:71]
    v_mfma_f32_16x16x32_bf16 a[72:75], v[116:119], v[100:103], a[72:75]
    v_mfma_f32_16x16x32_bf16 a[76:79], v[120:123], v[100:103], a[76:79]
    buffer_load_dwordx4 v[88:91], v3, s[16:19], s20 offen
    s_add_u32 s20, s20, 4096
    buffer_load_dwordx4 v[92:95], v3, s[16:19], s21 offen
    s_add_u32 s21, s21, 4096
    buffer_load_dwordx4 v[96:99], v3, s[16:19], s22 offen
    s_add_u32 s22, s22, 4096
    buffer_load_dwordx4 v[100:103], v3, s[16:19], s23 offen
    s_add_u32 s23, s23, 4096
    buffer_load_dwordx4 v[104:107], v3, s[16:19], s24 offen
    s_add_u32 s24, s24, 4096
    buffer_load_dwordx4 v[108:111], v3, s[16:19], s25 offen
    s_add_u32 s25, s25, 4096
    buffer_load_dwordx4 v[112:115], v3, s[16:19], s26 offen
    s_add_u32 s26, s26, 4096
    buffer_load_dwordx4 v[116:119], v3, s[16:19], s27 offen
    s_add_u32 s27, s27, 4096
    buffer_load_dwordx4 v[120:123], v3, s[16:19], s28 offen
    s_add_u32 s28, s28, 4096
    s_waitcnt vmcnt(27)
    v_mfma_f32_16x16x32_bf16 a[0:3], v[140:143], v[124:127], a[0:3]
    v_mfma_f32_16x16x32_bf16 a[4:7], v[144:147], v[124:127], a[4:7]
    v_mfma_f32_16x16x32_bf16 a[8:11], v[148:151], v[124:127], a[8:11]
    v_mfma_f32_16x16x32_bf16 a[12:15], v[152:155], v[124:127], a[12:15]
    v_mfma_f32_16x16x32_bf16 a[16:19], v[156:159], v[124:127], a[16:19]
    v_mfma_f32_16x16x32_bf16 a[20:23], v[140:143], v[128:131], a[20:23]
    v_mfma_f32_16x16x32_bf16 a[24:27], v[144:147], v[128:131], a[24:27]
    v_mfma_f32_16x16x32_bf16 a[28:31], v[148:151], v[128:131], a[28:31]
    v_mfma_f32_16x16x32_bf16 a[32:35], v[152:155], v[128:131], a[32:35]
    v_mfma_f32_16x16x32_bf16 a[36:39], v[156:159], v[128:131], a[36:39]
    v_mfma_f32_16x16x32_bf16 a[40:43], v[140:143], v[132:135], a[40:43]
    v_mfma_f32_16x16x32_bf16 a[44:47], v[144:147], v[132:135], a[44:47]
    v_mfma_f32_16x16x32_bf16 a[48:51], v[148:151], v[132:135], a[48:51]
    v_mfma_f32_16x16x32_bf16 a[52:55], v[152:155], v[132:135], a[52:55]
    v_mfma_f32_16x16x32_bf16 a[56:59], v[156:159], v[132:135], a[56:59]
    v_mfma_f32_16x16x32_bf16 a[60:63], v[140:143], v[136:139], a[60:63]
    v_mfma_f32_16x16x32_bf16 a[64:67], v[144:147], v[136:139], a[64:67]
    v_mfma_f32_16x16x32_bf16 a[68:71], v[148:151], v[136:139], a[68:71]
    v_mfma_f32_16x16x32_bf16 a[72:75], v[152:155], v[136:139], a[72:75]
    v_mfma_f32_16x16x32_bf16 a[76:79], v[156:159], v[136:139], a[76:79]
    buffer_load_dwordx4 v[124:127], v3, s[16:19], s20 offen
    s_add_u32 s20, s20, 4096
    buffer_load_dwordx4 v[128:131], v3, s[16:19], s21 offen
    s_add_u32 s21, s21, 4096
    buffer_load_dwordx4 v[132:135], v3, s[16:19], s22 offen
    s_add_u32 s22, s22, 4096
    buffer_load_dwordx4 v[136:139], v3, s[16:19], s23 offen
    s_add_u32 s23, s23, 4096
    buffer_load_dwordx4 v[140:143], v3, s[16:19], s24 offen
    s_add_u32 s24, s24, 4096
    buffer_load_dwordx4 v[144:147], v3, s[16:19], s25 offen
    s_add_u32 s25, s25, 4096
    buffer_load_dwordx4 v[148:151], v3, s[16:19], s26 offen
    s_add_u32 s26, s26, 4096
    buffer_load_dwordx4 v[152:155], v3, s[16:19], s27 offen
    s_add_u32 s27, s27, 4096
    buffer_load_dwordx4 v[156:159], v3, s[16:19], s28 offen
    s_add_u32 s28, s28, 4096
    s_waitcnt vmcnt(27)
    v_mfma_f32_16x16x32_bf16 a[0:3], v[32:35], v[16:19], a[0:3]
    v_mfma_f32_16x16x32_bf16 a[4:7], v[36:39], v[16:19], a[4:7]
    v_mfma_f32_16x16x32_bf16 a[8:11], v[40:43], v[16:19], a[8:11]
    v_mfma_f32_16x16x32_bf16 a[12:15], v[44:47], v[16:19], a[12:15]
    v_mfma_f32_16x16x32_bf16 a[16:19], v[48:51], v[16:19], a[16:19]
    v_mfma_f32_16x16x32_bf16 a[20:23], v[32:35], v[20:23], a[20:23]
    v_mfma_f32_16x16x32_bf16 a[24:27], v[36:39], v[20:23], a[24:27]
    v_mfma_f32_16x16x32_bf16 a[28:31], v[40:43], v[20:23], a[28:31]
    v_mfma_f32_16x16x32_bf16 a[32:35], v[44:47], v[20:23], a[32:35]
    v_mfma_f32_16x16x32_bf16 a[36:39], v[48:51], v[20:23], a[36:39]
    v_mfma_f32_16x16x32_bf16 a[40:43], v[32:35], v[24:27], a[40:43]
    v_mfma_f32_16x16x32_bf16 a[44:47], v[36:39], v[24:27], a[44:47]
    v_mfma_f32_16x16x32_bf16 a[48:51], v[40:43], v[24:27], a[48:51]
    v_mfma_f32_16x16x32_bf16 a[52:55], v[44:47], v[24:27], a[52:55]
    v_mfma_f32_16x16x32_bf16 a[56:59], v[48:51], v[24:27], a[56:59]
    v_mfma_f32_16x16x32_bf16 a[60:63], v[32:35], v[28:31], a[60:63]
    v_mfma_f32_16x16x32_bf16 a[64:67], v[36:39], v[28:31], a[64:67]
    v_mfma_f32_16x16x32_bf16 a[68:71], v[40:43], v[28:31], a[68:71]
    v_mfma_f32_16x16x32_bf16 a[72:75], v[44:47], v[28:31], a[72:75]
    v_mfma_f32_16x16x32_bf16 a[76:79], v[48:51], v[28:31], a[76:79]
    buffer_load_dwordx4 v[16:19], v3, s[16:19], s20 offen
    s_add_u32 s20, s20, 4096
    buffer_load_dwordx4 v[20:23], v3, s[16:19], s21 offen
    s_add_u32 s21, s21, 4096
    buffer_load_dwordx4 v[24:27], v3, s[16:19], s22 offen
    s_add_u32 s22, s22, 4096
    buffer_load_dwordx4 v[28:31], v3, s[16:19], s23 offen
    s_add_u32 s23, s23, 4096
    buffer_load_dwordx4 v[32:35], v3, s[16:19], s24 offen
    s_add_u32 s24, s24, 4096
    buffer_load_dwordx4 v[36:39], v3, s[16:19], s25 offen
    s_add_u32 s25, s25, 4096
    buffer_load_dwordx4 v[40:43], v3, s[16:19], s26 offen
    s_add_u32 s26, s26, 4096
    buffer_load_dwordx4 v[44:47], v3, s[16:19], s27 offen
    s_add_u32 s27, s27, 4096
    buffer_load_dwordx4 v[48:51], v3, s[16:19], s28 offen
    s_add_u32 s28, s28, 4096
    s_waitcnt vmcnt(27)
    v_mfma_f32_16x16x32_bf16 a[0:3], v[68:71], v[52:55], a[0:3]
    v_mfma_f32_16x16x32_bf16 a[4:7], v[72:75], v[52:55], a[4:7]
    v_mfma_f32_16x16x32_bf16 a[8:11], v[76:79], v[52:55], a[8:11]
    v_mfma_f32_16x16x32_bf16 a[12:15], v[80:83], v[52:55], a[12:15]
    v_mfma_f32_16x16x32_bf16 a[16:19], v[84:87], v[52:55], a[16:19]
    v_mfma_f32_16x16x32_bf16 a[20:23], v[68:71], v[56:59], a[20:23]
    v_mfma_f32_16x16x32_bf16 a[24:27], v[72:75], v[56:59], a[24:27]
    v_mfma_f32_16x16x32_bf16 a[28:31], v[76:79], v[56:59], a[28:31]
    v_mfma_f32_16x16x32_bf16 a[32:35], v[80:83], v[56:59], a[32:35]
    v_mfma_f32_16x16x32_bf16 a[36:39], v[84:87], v[56:59], a[36:39]
    v_mfma_f32_16x16x32_bf16 a[40:43], v[68:71], v[60:63], a[40:43]
    v_mfma_f32_16x16x32_bf16 a[44:47], v[72:75], v[60:63], a[44:47]
    v_mfma_f32_16x16x32_bf16 a[48:51], v[76:79], v[60:63], a[48:51]
    v_mfma_f32_16x16x32_bf16 a[52:55], v[80:83], v[60:63], a[52:55]
    v_mfma_f32_16x16x32_bf16 a[56:59], v[84:87], v[60:63], a[56:59]
    v_mfma_f32_16x16x32_bf16 a[60:63], v[68:71], v[64:67], a[60:63]
    v_mfma_f32_16x16x32_bf16 a[64:67], v[72:75], v[64:67], a[64:67]
    v_mfma_f32_16x16x32_bf16 a[68:71], v[76:79], v[64:67], a[68:71]
    v_mfma_f32_16x16x32_bf16 a[72:75], v[80:83], v[64:67], a[72:75]
    v_mfma_f32_16x16x32_bf16 a[76:79], v[84:87], v[64:67], a[76:79]
    buffer_load_dwordx4 v[52:55], v3, s[16:19], s20 offen
    s_add_u32 s20, s20, 4096
    buffer_load_dwordx4 v[56:59], v3, s[16:19], s21 offen
    s_add_u32 s21, s21, 4096
    buffer_load_dwordx4 v[60:63], v3, s[16:19], s22 offen
    s_add_u32 s22, s22, 4096
    buffer_load_dwordx4 v[64:67], v3, s[16:19], s23 offen
    s_add_u32 s23, s23, 4096
    buffer_load_dwordx4 v[68:71], v3, s[16:19], s24 offen
    s_add_u32 s24, s24, 4096
    buffer_load_dwordx4 v[72:75], v3, s[16:19], s25 offen
    s_add_u32 s25, s25, 4096
    buffer_load_dwordx4 v[76:79], v3, s[16:19], s26 offen
    s_add_u32 s26, s26, 4096
    buffer_load_dwordx4 v[80:83], v3, s[16:19], s27 offen
    s_add_u32 s27, s27, 4096
    buffer_load_dwordx4 v[84:87], v3, s[16:19], s28 offen
    s_add_u32 s28, s28, 4096
    s_waitcnt vmcnt(27)
    v_mfma_f32_16x16x32_bf16 a[0:3], v[104:107], v[88:91], a[0:3]
    v_mfma_f32_16x16x32_bf16 a[4:7], v[108:111], v[88:91], a[4:7]
    v_mfma_f32_16x16x32_bf16 a[8:11], v[112:115], v[88:91], a[8:11]
    v_mfma_f32_16x16x32_bf16 a[12:15], v[116:119], v[88:91], a[12:15]
    v_mfma_f32_16x16x32_bf16 a[16:19], v[120:123], v[88:91], a[16:19]
    v_mfma_f32_16x16x32_bf16 a[20:23], v[104:107], v[92:95], a[20:23]
    v_mfma_f32_16x16x32_bf16 a[24:27], v[108:111], v[92:95], a[24:27]
    v_mfma_f32_16x16x32_bf16 a[28:31], v[112:115], v[92:95], a[28:31]
    v_mfma_f32_16x16x32_bf16 a[32:35], v[116:119], v[92:95], a[32:35]
    v_mfma_f32_16x16x32_bf16 a[36:39], v[120:123], v[92:95], a[36:39]
    v_mfma_f32_16x16x32_bf16 a[40:43], v[104:107], v[96:99], a[40:43]
    v_mfma_f32_16x16x32_bf16 a[44:47], v[108:111], v[96:99], a[44:47]
    v_mfma_f32_16x16x32_bf16 a[48:51], v[112:115], v[96:99], a[48:51]
    v_mfma_f32_16x16x32_bf16 a[52:55], v[116:119], v[96:99], a[52:55]
    v_mfma_f32_16x16x32_bf16 a[56:59], v[120:123], v[96:99], a[56:59]
    v_mfma_f32_16x16x32_bf16 a[60:63], v[104:107], v[100:103], a[60:63]
    v_mfma_f32_16x16x32_bf16 a[64:67], v[108:111], v[100:103], a[64:67]
    v_mfma_f32_16x16x32_bf16 a[68:71], v[112:115], v[100:103], a[68:71]
    v_mfma_f32_16x16x32_bf16 a[72:75], v[116:119], v[100:103], a[72:75]
    v_mfma_f32_16x16x32_bf16 a[76:79], v[120:123], v[100:103], a[76:79]
    buffer_load_dwordx4 v[88:91], v3, s[16:19], s20 offen
    s_add_u32 s20, s20, 4096
    buffer_load_dwordx4 v[92:95], v3, s[16:19], s21 offen
    s_add_u32 s21, s21, 4096
    buffer_load_dwordx4 v[96:99], v3, s[16:19], s22 offen
    s_add_u32 s22, s22, 4096
    buffer_load_dwordx4 v[100:103], v3, s[16:19], s23 offen
    s_add_u32 s23, s23, 4096
    buffer_load_dwordx4 v[104:107], v3, s[16:19], s24 offen
    s_add_u32 s24, s24, 4096
    buffer_load_dwordx4 v[108:111], v3, s[16:19], s25 offen
    s_add_u32 s25, s25, 4096
    buffer_load_dwordx4 v[112:115], v3, s[16:19], s26 offen
    s_add_u32 s26, s26, 4096
    buffer_load_dwordx4 v[116:119], v3, s[16:19], s27 offen
    s_add_u32 s27, s27, 4096
    buffer_load_dwordx4 v[120:123], v3, s[16:19], s28 offen
    s_add_u32 s28, s28, 4096
    s_waitcnt vmcnt(27)
    v_mfma_f32_16x16x32_bf16 a[0:3], v[140:143], v[124:127], a[0:3]
    v_mfma_f32_16x16x32_bf16 a[4:7], v[144:147], v[124:127], a[4:7]
    v_mfma_f32_16x16x32_bf16 a[8:11], v[148:151], v[124:127], a[8:11]
    v_mfma_f32_16x16x32_bf16 a[12:15], v[152:155], v[124:127], a[12:15]
    v_mfma_f32_16x16x32_bf16 a[16:19], v[156:159], v[124:127], a[16:19]
    v_mfma_f32_16x16x32_bf16 a[20:23], v[140:143], v[128:131], a[20:23]
    v_mfma_f32_16x16x32_bf16 a[24:27], v[144:147], v[128:131], a[24:27]
    v_mfma_f32_16x16x32_bf16 a[28:31], v[148:151], v[128:131], a[28:31]
    v_mfma_f32_16x16x32_bf16 a[32:35], v[152:155], v[128:131], a[32:35]
    v_mfma_f32_16x16x32_bf16 a[36:39], v[156:159], v[128:131], a[36:39]
    v_mfma_f32_16x16x32_bf16 a[40:43], v[140:143], v[132:135], a[40:43]
    v_mfma_f32_16x16x32_bf16 a[44:47], v[144:147], v[132:135], a[44:47]
    v_mfma_f32_16x16x32_bf16 a[48:51], v[148:151], v[132:135], a[48:51]
    v_mfma_f32_16x16x32_bf16 a[52:55], v[152:155], v[132:135], a[52:55]
    v_mfma_f32_16x16x32_bf16 a[56:59], v[156:159], v[132:135], a[56:59]
    v_mfma_f32_16x16x32_bf16 a[60:63], v[140:143], v[136:139], a[60:63]
    v_mfma_f32_16x16x32_bf16 a[64:67], v[144:147], v[136:139], a[64:67]
    v_mfma_f32_16x16x32_bf16 a[68:71], v[148:151], v[136:139], a[68:71]
    v_mfma_f32_16x16x32_bf16 a[72:75], v[152:155], v[136:139], a[72:75]
    v_mfma_f32_16x16x32_bf16 a[76:79], v[156:159], v[136:139], a[76:79]
    buffer_load_dwordx4 v[124:127], v3, s[16:19], s20 offen
    s_add_u32 s20, s20, 4096
    buffer_load_dwordx4 v[128:131], v3, s[16:19], s21 offen
    s_add_u32 s21, s21, 4096
    buffer_load_dwordx4 v[132:135], v3, s[16:19], s22 offen
    s_add_u32 s22, s22, 4096
    buffer_load_dwordx4 v[136:139], v3, s[16:19], s23 offen
    s_add_u32 s23, s23, 4096
    buffer_load_dwordx4 v[140:143], v3, s[16:19], s24 offen
    s_add_u32 s24, s24, 4096
    buffer_load_dwordx4 v[144:147], v3, s[16:19], s25 offen
    s_add_u32 s25, s25, 4096
    buffer_load_dwordx4 v[148:151], v3, s[16:19], s26 offen
    s_add_u32 s26, s26, 4096
    buffer_load_dwordx4 v[152:155], v3, s[16:19], s27 offen
    s_add_u32 s27, s27, 4096
    buffer_load_dwordx4 v[156:159], v3, s[16:19], s28 offen
    s_add_u32 s28, s28, 4096
    s_waitcnt vmcnt(27)
    v_mfma_f32_16x16x32_bf16 a[0:3], v[32:35], v[16:19], a[0:3]
    v_mfma_f32_16x16x32_bf16 a[4:7], v[36:39], v[16:19], a[4:7]
    v_mfma_f32_16x16x32_bf16 a[8:11], v[40:43], v[16:19], a[8:11]
    v_mfma_f32_16x16x32_bf16 a[12:15], v[44:47], v[16:19], a[12:15]
    v_mfma_f32_16x16x32_bf16 a[16:19], v[48:51], v[16:19], a[16:19]
    v_mfma_f32_16x16x32_bf16 a[20:23], v[32:35], v[20:23], a[20:23]
    v_mfma_f32_16x16x32_bf16 a[24:27], v[36:39], v[20:23], a[24:27]
    v_mfma_f32_16x16x32_bf16 a[28:31], v[40:43], v[20:23], a[28:31]
    v_mfma_f32_16x16x32_bf16 a[32:35], v[44:47], v[20:23], a[32:35]
    v_mfma_f32_16x16x32_bf16 a[36:39], v[48:51], v[20:23], a[36:39]
    v_mfma_f32_16x16x32_bf16 a[40:43], v[32:35], v[24:27], a[40:43]
    v_mfma_f32_16x16x32_bf16 a[44:47], v[36:39], v[24:27], a[44:47]
    v_mfma_f32_16x16x32_bf16 a[48:51], v[40:43], v[24:27], a[48:51]
    v_mfma_f32_16x16x32_bf16 a[52:55], v[44:47], v[24:27], a[52:55]
    v_mfma_f32_16x16x32_bf16 a[56:59], v[48:51], v[24:27], a[56:59]
    v_mfma_f32_16x16x32_bf16 a[60:63], v[32:35], v[28:31], a[60:63]
    v_mfma_f32_16x16x32_bf16 a[64:67], v[36:39], v[28:31], a[64:67]
    v_mfma_f32_16x16x32_bf16 a[68:71], v[40:43], v[28:31], a[68:71]
    v_mfma_f32_16x16x32_bf16 a[72:75], v[44:47], v[28:31], a[72:75]
    v_mfma_f32_16x16x32_bf16 a[76:79], v[48:51], v[28:31], a[76:79]
    s_waitcnt vmcnt(18)
    v_mfma_f32_16x16x32_bf16 a[0:3], v[68:71], v[52:55], a[0:3]
    v_mfma_f32_16x16x32_bf16 a[4:7], v[72:75], v[52:55], a[4:7]
    v_mfma_f32_16x16x32_bf16 a[8:11], v[76:79], v[52:55], a[8:11]
    v_mfma_f32_16x16x32_bf16 a[12:15], v[80:83], v[52:55], a[12:15]
    v_mfma_f32_16x16x32_bf16 a[16:19], v[84:87], v[52:55], a[16:19]
    v_mfma_f32_16x16x32_bf16 a[20:23], v[68:71], v[56:59], a[20:23]
    v_mfma_f32_16x16x32_bf16 a[24:27], v[72:75], v[56:59], a[24:27]
    v_mfma_f32_16x16x32_bf16 a[28:31], v[76:79], v[56:59], a[28:31]
    v_mfma_f32_16x16x32_bf16 a[32:35], v[80:83], v[56:59], a[32:35]
    v_mfma_f32_16x16x32_bf16 a[36:39], v[84:87], v[56:59], a[36:39]
    v_mfma_f32_16x16x32_bf16 a[40:43], v[68:71], v[60:63], a[40:43]
    v_mfma_f32_16x16x32_bf16 a[44:47], v[72:75], v[60:63], a[44:47]
    v_mfma_f32_16x16x32_bf16 a[48:51], v[76:79], v[60:63], a[48:51]
    v_mfma_f32_16x16x32_bf16 a[52:55], v[80:83], v[60:63], a[52:55]
    v_mfma_f32_16x16x32_bf16 a[56:59], v[84:87], v[60:63], a[56:59]
    v_mfma_f32_16x16x32_bf16 a[60:63], v[68:71], v[64:67], a[60:63]
    v_mfma_f32_16x16x32_bf16 a[64:67], v[72:75], v[64:67], a[64:67]
    v_mfma_f32_16x16x32_bf16 a[68:71], v[76:79], v[64:67], a[68:71]
    v_mfma_f32_16x16x32_bf16 a[72:75], v[80:83], v[64:67], a[72:75]
    v_mfma_f32_16x16x32_bf16 a[76:79], v[84:87], v[64:67], a[76:79]
    s_waitcnt vmcnt(9)
    v_mfma_f32_16x16x32_bf16 a[0:3], v[104:107], v[88:91], a[0:3]
    v_mfma_f32_16x16x32_bf16 a[4:7], v[108:111], v[88:91], a[4:7]
    v_mfma_f32_16x16x32_bf16 a[8:11], v[112:115], v[88:91], a[8:11]
    v_mfma_f32_16x16x32_bf16 a[12:15], v[116:119], v[88:91], a[12:15]
    v_mfma_f32_16x16x32_bf16 a[16:19], v[120:123], v[88:91], a[16:19]
    v_mfma_f32_16x16x32_bf16 a[20:23], v[104:107], v[92:95], a[20:23]
    v_mfma_f32_16x16x32_bf16 a[24:27], v[108:111], v[92:95], a[24:27]
    v_mfma_f32_16x16x32_bf16 a[28:31], v[112:115], v[92:95], a[28:31]
    v_mfma_f32_16x16x32_bf16 a[32:35], v[116:119], v[92:95], a[32:35]
    v_mfma_f32_16x16x32_bf16 a[36:39], v[120:123], v[92:95], a[36:39]
    v_mfma_f32_16x16x32_bf16 a[40:43], v[104:107], v[96:99], a[40:43]
    v_mfma_f32_16x16x32_bf16 a[44:47], v[108:111], v[96:99], a[44:47]
    v_mfma_f32_16x16x32_bf16 a[48:51], v[112:115], v[96:99], a[48:51]
    v_mfma_f32_16x16x32_bf16 a[52:55], v[116:119], v[96:99], a[52:55]
    v_mfma_f32_16x16x32_bf16 a[56:59], v[120:123], v[96:99], a[56:59]
    v_mfma_f32_16x16x32_bf16 a[60:63], v[104:107], v[100:103], a[60:63]
    v_mfma_f32_16x16x32_bf16 a[64:67], v[108:111], v[100:103], a[64:67]
    v_mfma_f32_16x16x32_bf16 a[68:71], v[112:115], v[100:103], a[68:71]
    v_mfma_f32_16x16x32_bf16 a[72:75], v[116:119], v[100:103], a[72:75]
    v_mfma_f32_16x16x32_bf16 a[76:79], v[120:123], v[100:103], a[76:79]
    s_waitcnt vmcnt(0)
    v_mfma_f32_16x16x32_bf16 a[0:3], v[140:143], v[124:127], a[0:3]
    v_mfma_f32_16x16x32_bf16 a[4:7], v[144:147], v[124:127], a[4:7]
    v_mfma_f32_16x16x32_bf16 a[8:11], v[148:151], v[124:127], a[8:11]
    v_mfma_f32_16x16x32_bf16 a[12:15], v[152:155], v[124:127], a[12:15]
    v_mfma_f32_16x16x32_bf16 a[16:19], v[156:159], v[124:127], a[16:19]
    v_mfma_f32_16x16x32_bf16 a[20:23], v[140:143], v[128:131], a[20:23]
    v_mfma_f32_16x16x32_bf16 a[24:27], v[144:147], v[128:131], a[24:27]
    v_mfma_f32_16x16x32_bf16 a[28:31], v[148:151], v[128:131], a[28:31]
    v_mfma_f32_16x16x32_bf16 a[32:35], v[152:155], v[128:131], a[32:35]
    v_mfma_f32_16x16x32_bf16 a[36:39], v[156:159], v[128:131], a[36:39]
    v_mfma_f32_16x16x32_bf16 a[40:43], v[140:143], v[132:135], a[40:43]
    v_mfma_f32_16x16x32_bf16 a[44:47], v[144:147], v[132:135], a[44:47]
    v_mfma_f32_16x16x32_bf16 a[48:51], v[148:151], v[132:135], a[48:51]
    v_mfma_f32_16x16x32_bf16 a[52:55], v[152:155], v[132:135], a[52:55]
    v_mfma_f32_16x16x32_bf16 a[56:59], v[156:159], v[132:135], a[56:59]
    v_mfma_f32_16x16x32_bf16 a[60:63], v[140:143], v[136:139], a[60:63]
    v_mfma_f32_16x16x32_bf16 a[64:67], v[144:147], v[136:139], a[64:67]
    v_mfma_f32_16x16x32_bf16 a[68:71], v[148:151], v[136:139], a[68:71]
    v_mfma_f32_16x16x32_bf16 a[72:75], v[152:155], v[136:139], a[72:75]
    v_mfma_f32_16x16x32_bf16 a[76:79], v[156:159], v[136:139], a[76:79]
    s_nop 7
    s_mul_i32 s15, s3, 20480
    v_add_u32 v5, s15, v3
    s_cmp_eq_u32 s3, 0
    s_cbranch_scc1 L_k5sk_16
    ds_write_b128 v5, a[0:3] offset:0
    ds_write_b128 v5, a[4:7] offset:1024
    ds_write_b128 v5, a[8:11] offset:2048
    ds_write_b128 v5, a[12:15] offset:3072
    ds_write_b128 v5, a[16:19] offset:4096
L_k5sk_16:
    s_cmp_eq_u32 s3, 1
    s_cbranch_scc1 L_k5sk_17
    ds_write_b128 v5, a[20:23] offset:5120
    ds_write_b128 v5, a[24:27] offset:6144
    ds_write_b128 v5, a[28:31] offset:7168
    ds_write_b128 v5, a[32:35] offset:8192
    ds_write_b128 v5, a[36:39] offset:9216
L_k5sk_17:
    s_cmp_eq_u32 s3, 2
    s_cbranch_scc1 L_k5sk_18
    ds_write_b128 v5, a[40:43] offset:10240
    ds_write_b128 v5, a[44:47] offset:11264
    ds_write_b128 v5, a[48:51] offset:12288
    ds_write_b128 v5, a[52:55] offset:13312
    ds_write_b128 v5, a[56:59] offset:14336
L_k5sk_18:
    s_cmp_eq_u32 s3, 3
    s_cbranch_scc1 L_k5sk_19
    ds_write_b128 v5, a[60:63] offset:15360
    ds_write_b128 v5, a[64:67] offset:16384
    ds_write_b128 v5, a[68:71] offset:17408
    ds_write_b128 v5, a[72:75] offset:18432
    ds_write_b128 v5, a[76:79] offset:19456
L_k5sk_19:
    s_cmp_lg_u32 s3, 0
    s_cbranch_scc1 L_k5o_21
    v_accvgpr_read_b32 v16, a0
    v_accvgpr_read_b32 v17, a1
    v_accvgpr_read_b32 v18, a2
    v_accvgpr_read_b32 v19, a3
    v_accvgpr_read_b32 v20, a4
    v_accvgpr_read_b32 v21, a5
    v_accvgpr_read_b32 v22, a6
    v_accvgpr_read_b32 v23, a7
    v_accvgpr_read_b32 v24, a8
    v_accvgpr_read_b32 v25, a9
    v_accvgpr_read_b32 v26, a10
    v_accvgpr_read_b32 v27, a11
    v_accvgpr_read_b32 v28, a12
    v_accvgpr_read_b32 v29, a13
    v_accvgpr_read_b32 v30, a14
    v_accvgpr_read_b32 v31, a15
    v_accvgpr_read_b32 v32, a16
    v_accvgpr_read_b32 v33, a17
    v_accvgpr_read_b32 v34, a18
    v_accvgpr_read_b32 v35, a19
    s_branch L_k5own_20
L_k5o_21:
    s_cmp_lg_u32 s3, 1
    s_cbranch_scc1 L_k5o_22
    v_accvgpr_read_b32 v16, a20
    v_accvgpr_read_b32 v17, a21
    v_accvgpr_read_b32 v18, a22
    v_accvgpr_read_b32 v19, a23
    v_accvgpr_read_b32 v20, a24
    v_accvgpr_read_b32 v21, a25
    v_accvgpr_read_b32 v22, a26
    v_accvgpr_read_b32 v23, a27
    v_accvgpr_read_b32 v24, a28
    v_accvgpr_read_b32 v25, a29
    v_accvgpr_read_b32 v26, a30
    v_accvgpr_read_b32 v27, a31
    v_accvgpr_read_b32 v28, a32
    v_accvgpr_read_b32 v29, a33
    v_accvgpr_read_b32 v30, a34
    v_accvgpr_read_b32 v31, a35
    v_accvgpr_read_b32 v32, a36
    v_accvgpr_read_b32 v33, a37
    v_accvgpr_read_b32 v34, a38
    v_accvgpr_read_b32 v35, a39
    s_branch L_k5own_20
L_k5o_22:
    s_cmp_lg_u32 s3, 2
    s_cbranch_scc1 L_k5o_23
    v_accvgpr_read_b32 v16, a40
    v_accvgpr_read_b32 v17, a41
    v_accvgpr_read_b32 v18, a42
    v_accvgpr_read_b32 v19, a43
    v_accvgpr_read_b32 v20, a44
    v_accvgpr_read_b32 v21, a45
    v_accvgpr_read_b32 v22, a46
    v_accvgpr_read_b32 v23, a47
    v_accvgpr_read_b32 v24, a48
    v_accvgpr_read_b32 v25, a49
    v_accvgpr_read_b32 v26, a50
    v_accvgpr_read_b32 v27, a51
    v_accvgpr_read_b32 v28, a52
    v_accvgpr_read_b32 v29, a53
    v_accvgpr_read_b32 v30, a54
    v_accvgpr_read_b32 v31, a55
    v_accvgpr_read_b32 v32, a56
    v_accvgpr_read_b32 v33, a57
    v_accvgpr_read_b32 v34, a58
    v_accvgpr_read_b32 v35, a59
    s_branch L_k5own_20
L_k5o_23:
    s_cmp_lg_u32 s3, 3
    s_cbranch_scc1 L_k5o_24
    v_accvgpr_read_b32 v16, a60
    v_accvgpr_read_b32 v17, a61
    v_accvgpr_read_b32 v18, a62
    v_accvgpr_read_b32 v19, a63
    v_accvgpr_read_b32 v20, a64
    v_accvgpr_read_b32 v21, a65
    v_accvgpr_read_b32 v22, a66
    v_accvgpr_read_b32 v23, a67
    v_accvgpr_read_b32 v24, a68
    v_accvgpr_read_b32 v25, a69
    v_accvgpr_read_b32 v26, a70
    v_accvgpr_read_b32 v27, a71
    v_accvgpr_read_b32 v28, a72
    v_accvgpr_read_b32 v29, a73
    v_accvgpr_read_b32 v30, a74
    v_accvgpr_read_b32 v31, a75
    v_accvgpr_read_b32 v32, a76
    v_accvgpr_read_b32 v33, a77
    v_accvgpr_read_b32 v34, a78
    v_accvgpr_read_b32 v35, a79
    s_branch L_k5own_20
L_k5o_24:
L_k5own_20:
    s_waitcnt lgkmcnt(0)
    s_barrier
    s_mul_i32 s15, s3, 5120
    v_add_u32 v5, s15, v3
    s_add_u32 s22, s3, 1
    s_and_b32 s22, s22, 3
    s_mul_i32 s22, s22, 20480
    v_add_u32 v37, s22, v5
    s_add_u32 s22, s3, 2
    s_and_b32 s22, s22, 3
    s_mul_i32 s22, s22, 20480
    v_add_u32 v38, s22, v5
    s_add_u32 s22, s3, 3
    s_and_b32 s22, s22, 3
    s_mul_i32 s22, s22, 20480
    v_add_u32 v39, s22, v5
    ds_read_b128 v[40:43], v37 offset:0
    ds_read_b128 v[44:47], v37 offset:1024
    ds_read_b128 v[48:51], v37 offset:2048
    ds_read_b128 v[52:55], v37 offset:3072
    ds_read_b128 v[56:59], v37 offset:4096
    ds_read_b128 v[60:63], v38 offset:0
    ds_read_b128 v[64:67], v38 offset:1024
    ds_read_b128 v[68:71], v38 offset:2048
    ds_read_b128 v[72:75], v38 offset:3072
    ds_read_b128 v[76:79], v38 offset:4096
    ds_read_b128 v[80:83], v39 offset:0
    ds_read_b128 v[84:87], v39 offset:1024
    ds_read_b128 v[88:91], v39 offset:2048
    ds_read_b128 v[92:95], v39 offset:3072
    ds_read_b128 v[96:99], v39 offset:4096
    s_waitcnt lgkmcnt(0)
    v_pk_add_f32 v[16:17], v[16:17], v[40:41]
    v_pk_add_f32 v[18:19], v[18:19], v[42:43]
    v_pk_add_f32 v[20:21], v[20:21], v[44:45]
    v_pk_add_f32 v[22:23], v[22:23], v[46:47]
    v_pk_add_f32 v[24:25], v[24:25], v[48:49]
    v_pk_add_f32 v[26:27], v[26:27], v[50:51]
    v_pk_add_f32 v[28:29], v[28:29], v[52:53]
    v_pk_add_f32 v[30:31], v[30:31], v[54:55]
    v_pk_add_f32 v[32:33], v[32:33], v[56:57]
    v_pk_add_f32 v[34:35], v[34:35], v[58:59]
    v_pk_add_f32 v[16:17], v[16:17], v[60:61]
    v_pk_add_f32 v[18:19], v[18:19], v[62:63]
    v_pk_add_f32 v[20:21], v[20:21], v[64:65]
    v_pk_add_f32 v[22:23], v[22:23], v[66:67]
    v_pk_add_f32 v[24:25], v[24:25], v[68:69]
    v_pk_add_f32 v[26:27], v[26:27], v[70:71]
    v_pk_add_f32 v[28:29], v[28:29], v[72:73]
    v_pk_add_f32 v[30:31], v[30:31], v[74:75]
    v_pk_add_f32 v[32:33], v[32:33], v[76:77]
    v_pk_add_f32 v[34:35], v[34:35], v[78:79]
    v_pk_add_f32 v[16:17], v[16:17], v[80:81]
    v_pk_add_f32 v[18:19], v[18:19], v[82:83]
    v_pk_add_f32 v[20:21], v[20:21], v[84:85]
    v_pk_add_f32 v[22:23], v[22:23], v[86:87]
    v_pk_add_f32 v[24:25], v[24:25], v[88:89]
    v_pk_add_f32 v[26:27], v[26:27], v[90:91]
    v_pk_add_f32 v[28:29], v[28:29], v[92:93]
    v_pk_add_f32 v[30:31], v[30:31], v[94:95]
    v_pk_add_f32 v[32:33], v[32:33], v[96:97]
    v_pk_add_f32 v[34:35], v[34:35], v[98:99]
    s_waitcnt vmcnt(0)
    v_cvt_pk_bf16_f32 v17, v16, v17
    v_lshlrev_b32 v16, 16, v17
    v_and_b32 v17, 0xffff0000, v17
    v_lshlrev_b32 v40, 16, v6
    v_and_b32 v41, 0xffff0000, v6
    v_pk_add_f32 v[16:17], v[16:17], v[40:41]
    v_cvt_pk_bf16_f32 v6, v16, v17
    v_cvt_pk_bf16_f32 v19, v18, v19
    v_lshlrev_b32 v18, 16, v19
    v_and_b32 v19, 0xffff0000, v19
    v_lshlrev_b32 v40, 16, v7
    v_and_b32 v41, 0xffff0000, v7
    v_pk_add_f32 v[18:19], v[18:19], v[40:41]
    v_cvt_pk_bf16_f32 v7, v18, v19
    buffer_store_dwordx2 v[6:7], v4, s[32:35], s13 offen offset:0
    v_cvt_pk_bf16_f32 v21, v20, v21
    v_lshlrev_b32 v20, 16, v21
    v_and_b32 v21, 0xffff0000, v21
    v_lshlrev_b32 v40, 16, v8
    v_and_b32 v41, 0xffff0000, v8
    v_pk_add_f32 v[20:21], v[20:21], v[40:41]
    v_cvt_pk_bf16_f32 v8, v20, v21
    v_cvt_pk_bf16_f32 v23, v22, v23
    v_lshlrev_b32 v22, 16, v23
    v_and_b32 v23, 0xffff0000, v23
    v_lshlrev_b32 v40, 16, v9
    v_and_b32 v41, 0xffff0000, v9
    v_pk_add_f32 v[22:23], v[22:23], v[40:41]
    v_cvt_pk_bf16_f32 v9, v22, v23
    buffer_store_dwordx2 v[8:9], v4, s[32:35], s13 offen offset:32
    v_cvt_pk_bf16_f32 v25, v24, v25
    v_lshlrev_b32 v24, 16, v25
    v_and_b32 v25, 0xffff0000, v25
    v_lshlrev_b32 v40, 16, v10
    v_and_b32 v41, 0xffff0000, v10
    v_pk_add_f32 v[24:25], v[24:25], v[40:41]
    v_cvt_pk_bf16_f32 v10, v24, v25
    v_cvt_pk_bf16_f32 v27, v26, v27
    v_lshlrev_b32 v26, 16, v27
    v_and_b32 v27, 0xffff0000, v27
    v_lshlrev_b32 v40, 16, v11
    v_and_b32 v41, 0xffff0000, v11
    v_pk_add_f32 v[26:27], v[26:27], v[40:41]
    v_cvt_pk_bf16_f32 v11, v26, v27
    buffer_store_dwordx2 v[10:11], v4, s[32:35], s13 offen offset:64
    v_cvt_pk_bf16_f32 v29, v28, v29
    v_lshlrev_b32 v28, 16, v29
    v_and_b32 v29, 0xffff0000, v29
    v_lshlrev_b32 v40, 16, v12
    v_and_b32 v41, 0xffff0000, v12
    v_pk_add_f32 v[28:29], v[28:29], v[40:41]
    v_cvt_pk_bf16_f32 v12, v28, v29
    v_cvt_pk_bf16_f32 v31, v30, v31
    v_lshlrev_b32 v30, 16, v31
    v_and_b32 v31, 0xffff0000, v31
    v_lshlrev_b32 v40, 16, v13
    v_and_b32 v41, 0xffff0000, v13
    v_pk_add_f32 v[30:31], v[30:31], v[40:41]
    v_cvt_pk_bf16_f32 v13, v30, v31
    buffer_store_dwordx2 v[12:13], v4, s[32:35], s13 offen offset:96
    v_cvt_pk_bf16_f32 v33, v32, v33
    v_lshlrev_b32 v32, 16, v33
    v_and_b32 v33, 0xffff0000, v33
    v_lshlrev_b32 v40, 16, v14
    v_and_b32 v41, 0xffff0000, v14
    v_pk_add_f32 v[32:33], v[32:33], v[40:41]
    v_cvt_pk_bf16_f32 v14, v32, v33
    v_cvt_pk_bf16_f32 v35, v34, v35
    v_lshlrev_b32 v34, 16, v35
    v_and_b32 v35, 0xffff0000, v35
    v_lshlrev_b32 v40, 16, v15
    v_and_b32 v41, 0xffff0000, v15
    v_pk_add_f32 v[34:35], v[34:35], v[40:41]
    v_cvt_pk_bf16_f32 v15, v34, v35
    buffer_store_dwordx2 v[14:15], v4, s[32:35], s13 offen offset:128
L_k5end_15:
    s_endpgm
.section .rodata,"a"
.p2align 6
.amdhsa_kernel k1_kernel
  .amdhsa_next_free_vgpr 84
  .amdhsa_next_free_sgpr 100
  .amdhsa_accum_offset 84
  .amdhsa_group_segment_fixed_size 0
  .amdhsa_kernarg_size 80
  .amdhsa_user_sgpr_count 2
  .amdhsa_user_sgpr_kernarg_segment_ptr 1
  .amdhsa_system_sgpr_workgroup_id_x 1
.end_amdhsa_kernel
.p2align 6
.amdhsa_kernel k2_kernel
  .amdhsa_next_free_vgpr 100
  .amdhsa_next_free_sgpr 100
  .amdhsa_accum_offset 100
  .amdhsa_group_segment_fixed_size 0
  .amdhsa_kernarg_size 80
  .amdhsa_user_sgpr_count 2
  .amdhsa_user_sgpr_kernarg_segment_ptr 1
  .amdhsa_system_sgpr_workgroup_id_x 1
.end_amdhsa_kernel
.p2align 6
.amdhsa_kernel k3_kernel
  .amdhsa_next_free_vgpr 96
  .amdhsa_next_free_sgpr 100
  .amdhsa_accum_offset 96
  .amdhsa_group_segment_fixed_size 0
  .amdhsa_kernarg_size 80
  .amdhsa_user_sgpr_count 2
  .amdhsa_user_sgpr_kernarg_segment_ptr 1
  .amdhsa_system_sgpr_workgroup_id_x 1
.end_amdhsa_kernel
.p2align 6
.amdhsa_kernel k4_kernel
  .amdhsa_next_free_vgpr 132
  .amdhsa_next_free_sgpr 100
  .amdhsa_accum_offset 132
  .amdhsa_group_segment_fixed_size 0
  .amdhsa_kernarg_size 80
  .amdhsa_user_sgpr_count 2
  .amdhsa_user_sgpr_kernarg_segment_ptr 1
  .amdhsa_system_sgpr_workgroup_id_x 1
.end_amdhsa_kernel
.p2align 6
.amdhsa_kernel k5_kernel
  .amdhsa_next_free_vgpr 240
  .amdhsa_next_free_sgpr 100
  .amdhsa_accum_offset 160
  .amdhsa_group_segment_fixed_size 0
  .amdhsa_kernarg_size 80
  .amdhsa_user_sgpr_count 2
  .amdhsa_user_sgpr_kernarg_segment_ptr 1
  .amdhsa_system_sgpr_workgroup_id_x 1
.end_amdhsa_kernel
```
